```python
import torch

def _softmax(x, axis=-1):
    return torch.softmax(x, dim=axis)
def _gelu(x):
    return torch.nn.functional.gelu(x, approximate="tanh")
def _silu(x):
    return torch.nn.functional.silu(x)
def _sigmoid(x):
    return torch.sigmoid(x)
def _layernorm(x, axis=-1, eps=1e-5):
    m = x.mean(dim=axis, keepdim=True)
    v = x.var(dim=axis, keepdim=True, unbiased=False)
    return (x - m) / torch.sqrt(v + eps)
def _scatter_add(tgt, idx, src, axis=0):
    return tgt.clone().index_add_(axis, idx, src)
def _segment_sum(src, seg, n):
    out = torch.zeros((n,) + src.shape[1:], dtype=src.dtype)
    return out.index_add_(0, seg, src)
def _pad(x, pw):
    flat = tuple(v for pair in reversed(pw) for v in pair)
    return torch.nn.functional.pad(x, flat)

kernel_name = 'gated_mix__mha_block__linear_attn_block__prompt'

def setup_inputs():

    _w = (lambda a: (lambda t: t.to(torch.bfloat16) if t.is_floating_point() else t)(torch.as_tensor(a)))
    def _A_setup():
        B, S, D, H = 1, 2048, 448, 16
        return {
            "x": _w((lambda *s: torch.randn(*s, dtype=torch.bfloat16) * 0.05)(B, S, D)),
            "wqkv": _w((lambda *s: torch.randn(*s, dtype=torch.bfloat16) * 0.8)(D, 3 * D)),
            "wo": _w((lambda *s: torch.randn(*s, dtype=torch.bfloat16) * 0.05)(D, D)),
        }
    _A_in = _A_setup()

    def _B_setup():
        B, S, D = 1, 2048, 448
        return {
            "x": _w((lambda *s: torch.randn(*s, dtype=torch.bfloat16) * 0.05)(B, S, D)),
            "wqkv": _w((lambda *s: torch.randn(*s, dtype=torch.bfloat16) * 0.8)(D, 3 * D)),
            "wo": _w((lambda *s: torch.randn(*s, dtype=torch.bfloat16) * 0.1)(D, D)),
        }
    _B_in = _B_setup()

    return {
        "A_x": _A_in["x"],
        "A_wqkv": _A_in["wqkv"],
        "A_wo": _A_in["wo"],
        "B_x": _B_in["x"],
        "B_wqkv": _B_in["wqkv"],
        "B_wo": _B_in["wo"],
        "gate_w": _w((lambda *s: torch.randn(*s, dtype=torch.bfloat16) * 0.05)(448) * 16.0),
    }

def reference(A_x, A_wqkv, A_wo, B_x, B_wqkv, B_wo, gate_w):
    def _A_ref(x, wqkv, wo):
        B, S, D = x.shape
        H = 16
        Dh = D // H
        qkv = (lambda x, *d: x.permute(*d))((x @ wqkv).reshape(B, S, 3, H, Dh), 2, 0, 3, 1, 4)
        q, k, v = qkv[0], qkv[1], qkv[2]
        scores = torch.einsum("bhqd,bhkd->bhqk", q, k) * (Dh ** -0.5)
        p = _softmax(scores, axis=-1)
        o = torch.einsum("bhqk,bhkd->bhqd", p, v)
        return (lambda x, *d: x.permute(*d))(o, 0, 2, 1, 3).reshape(B, S, D) @ wo

    def _B_ref(x, wqkv, wo):
        B, S, D = x.shape
        H = 16; Dh = D // H
        qkv = (lambda x, *d: x.permute(*d))((x @ wqkv).reshape(B, S, 3, H, Dh), 2, 0, 3, 1, 4)
        q, k, v = qkv[0], qkv[1], qkv[2]
        phi = lambda t: torch.where(t > 0, t + 1, torch.exp(t)) + 1e-6
        pq, pk = phi(q), phi(k)
        kv = torch.einsum("bhsd,bhse->bhde", pk, v)
        z = torch.einsum("bhsd->bhd", pk)
        num = torch.einsum("bhqd,bhde->bhqe", pq, kv)
        den = torch.einsum("bhqd,bhd->bhq", pq, z)[..., None] + 1e-6
        o = num / den
        return (lambda x, *d: x.permute(*d))(o, 0, 2, 1, 3).reshape(B, S, D) @ wo

    x = A_x
    g = _sigmoid((x * gate_w).sum(-1, keepdims=True))
    a = _A_ref(x, A_wqkv, A_wo)
    b = _B_ref(x, B_wqkv, B_wo)
    return g * a + (1 - g) * b
```

```asm
; @launch grid=(256,1,1) block=(256,1,1) lds=163840
.amdgcn_target "amdgcn-amd-amdhsa--gfx950"
.text
.globl gated_mix__mha_block__linear_attn_block__prompt_kernel
.p2align 8
.type gated_mix__mha_block__linear_attn_block__prompt_kernel,@function
gated_mix__mha_block__linear_attn_block__prompt_kernel:
    s_cmp_ge_u32 s2, 256
    s_cbranch_scc1 L_f_end
    s_load_dwordx2 s[64:65], s[0:1], 72
    s_load_dwordx8 s[4:11], s[0:1], 0
    s_load_dwordx8 s[56:63], s[0:1], 32
    v_lshrrev_b32 v2, 6, v0
    v_and_b32 v1, 63, v0
    v_readfirstlane_b32 s36, v2
    s_getpc_b64 s[14:15]
L_f_pc:
    s_lshr_b32 s3, s2, 3
    s_lshl_b32 s3, s3, 2
    s_add_u32 s3, s3, s36
    s_lshl_b32 s40, s3, 9
    v_and_b32 v2, 3, v1
    v_lshl_add_u32 v2, v2, 7, s40
    v_min_u32 v2, L_f_end-L_f_pc, v2
    global_load_dword v215, v2, s[14:15]
    s_and_b32 s43, s2, 3
    s_lshr_b32 s41, s2, 5
    s_bfe_u32 s38, s2, 0x10002
    s_lshl_b32 s38, s38, 3
    s_add_u32 s38, s38, s41
    s_bfe_u32 s40, s2, 0x20003
    s_lshl_b32 s37, s43, 2
    s_add_u32 s37, s37, s40
    s_lshl_b32 s40, s37, 1
    s_lshr_b32 s39, 0x4ed8726c, s40
    s_and_b32 s39, s39, 3
    s_bfe_u32 s40, s2, 0x20003
    s_lshr_b32 s41, s2, 5
    s_lshl_b32 s41, s41, 1
    s_add_u32 s40, s40, s41
    s_lshl_b32 s40, s40, 1
    s_and_b32 s41, s2, 7
    s_add_u32 s40, s40, s41
    s_mul_i32 s41, s40, 37
    s_lshr_b32 s41, s41, 8
    s_mul_i32 s41, s41, 7
    s_sub_u32 s44, s40, s41
    s_mov_b32 s53, s44
    s_and_b32 s47, s36, 1
    s_lshr_b32 s48, s36, 1
    s_lshr_b32 s51, s39, 1
    s_lshl_b32 s40, s38, 2
    s_add_u32 s40, s40, s36
    s_mul_i32 s45, s40, 28672
    s_mul_i32 s46, s36, 43008
    s_lshl_b32 s49, s36, 12
    s_add_u32 s50, s49, 16384
    v_lshrrev_b32 v2, 3, v1
    v_and_b32 v3, 7, v1
    v_xor_b32 v4, v2, v3
    v_lshlrev_b32 v4, 4, v4
    v_mul_u32_u24 v5, 896, v2
    v_add_u32 v218, v4, v5
    v_xor_b32 v219, 16, v218
    s_lshl_b32 s40, s43, 1
    s_and_b32 s41, s39, 1
    s_add_u32 s40, s40, s41
    s_mul_i32 s40, s40, 112
    s_add_u32 s40, s40, 896
    s_add_u32 s41, s39, 1
    s_mul_i32 s41, s41, 896
    s_mul_i32 s42, s43, 224
    s_add_u32 s41, s41, s42
    s_cmp_lt_u32 s39, 2
    s_cselect_b32 s40, s41, s40
    s_cselect_b32 s41, 4, 3
    s_cselect_b32 s42, 15, 7
    s_cselect_b32 s54, 13, 6
    v_lshrrev_b32 v2, 4, v1
    v_lshlrev_b32 v3, 2, v2
    v_sub_u32 v3, v1, v3
    v_and_b32 v3, 15, v3
    v_lshrrev_b32 v4, s41, v3
    v_mul_u32_u24 v4, 896, v4
    v_and_b32 v3, s42, v3
    v_min_u32 v3, s54, v3
    v_lshl_add_u32 v3, v3, 4, v4
    v_mul_u32_u24 v5, 2688, v2
    v_add3_u32 v220, v3, v5, s40
    s_waitcnt lgkmcnt(0)
    s_mov_b32 s24, s8
    s_mov_b32 s25, s9
    s_mov_b32 s12, s6
    s_mov_b32 s13, s7
    s_cmp_lt_u32 s39, 2
    s_cselect_b32 s8, s6, s56
    s_cselect_b32 s9, s7, s57
    s_mov_b32 s10, 0x126000
    s_mov_b32 s11, 0x20000
    s_mov_b32 s6, 0x1c0000
    s_mov_b32 s7, 0x20000
    s_lshl_b32 s40, s44, 7
    s_add_u32 m0, s49, 0
    s_add_u32 s40, s40, s45
    buffer_load_dwordx4 v218, s[4:7], s40 offen offset:0 lds
    s_add_u32 s40, s40, 6144
    buffer_load_dwordx4 v218, s[4:7], s40 offen offset:1024 lds
    s_add_u32 s40, s40, 6144
    buffer_load_dwordx4 v219, s[4:7], s40 offen offset:2048 lds
    s_add_u32 s40, s40, 6144
    buffer_load_dwordx4 v219, s[4:7], s40 offen offset:3072 lds
    s_mul_i32 s41, s44, 172032
    s_add_u32 m0, s50, 0
    s_add_u32 s41, s41, s46
    buffer_load_dwordx4 v220, s[8:11], s41 offen offset:0 lds
    s_add_u32 s41, s41, 9728
    buffer_load_dwordx4 v220, s[8:11], s41 offen offset:1024 lds
    s_add_u32 s41, s41, 9728
    buffer_load_dwordx4 v220, s[8:11], s41 offen offset:2048 lds
    s_add_u32 s41, s41, 9728
    buffer_load_dwordx4 v220, s[8:11], s41 offen offset:3072 lds
    s_add_u32 s44, s44, 1
    s_cmp_eq_u32 s44, 7
    s_cselect_b32 s44, 0, s44
    s_mov_b32 s26, 0x62000
    s_mov_b32 s27, 0x20000
    s_mov_b32 s16, s64
    s_mov_b32 s17, s65
    s_mov_b32 s18, 0xf00000
    s_mov_b32 s19, 0x20000
    s_mov_b32 s28, s58
    s_mov_b32 s29, s59
    s_mov_b32 s30, 0x62000
    s_mov_b32 s31, 0x20000
    s_mov_b32 s20, s62
    s_mov_b32 s21, s63
    s_mov_b32 s22, 0x1c0000
    s_mov_b32 s23, 0x20000
    v_lshlrev_b32 v6, 4, v1
    s_mul_i32 s40, s38, 28
    s_mul_i32 s41, s36, 7
    s_add_u32 s40, s40, s41
    v_lshrrev_b32 v2, 3, v1
    v_min_u32 v2, 6, v2
    v_add_u32 v2, s40, v2
    v_and_b32 v3, 3, v1
    v_mul_u32_u24 v4, 2688, v2
    v_lshl_add_u32 v4, v3, 4, v4
    s_mul_i32 s41, s37, 56
    v_add_u32 v4, s41, v4
    v_and_b32 v5, 4, v1
    v_cmp_eq_u32 vcc, 0, v5
    v_mov_b32 v212, s56
    v_mov_b32 v213, s57
    v_mov_b32 v228, s12
    v_mov_b32 v229, s13
    v_cndmask_b32 v212, v212, v228, vcc
    v_cndmask_b32 v213, v213, v229, vcc
    v_add_co_u32 v212, vcc, v212, v4
    s_nop 1
    v_addc_co_u32 v213, vcc, 0, v213, vcc
    global_load_dwordx4 v[228:231], v[212:213], off
    v_lshlrev_b32 v4, 1, v2
    global_load_ushort v211, v4, s[60:61]
    v_lshlrev_b32 v4, 1, v2
    v_and_b32 v4, 4, v4
    v_and_b32 v3, 7, v1
    v_xor_b32 v3, v3, v4
    v_lshlrev_b32 v3, 4, v3
    v_lshl_add_u32 v3, v2, 7, v3
    s_mul_i32 s40, s37, 57344
    s_add_u32 s40, s40, 0x400000
    v_add_u32 v214, s40, v3
    s_lshl_b32 s41, s36, 11
    s_add_u32 s32, s40, s41
    s_lshl_b32 s40, s37, 11
    s_add_u32 s40, s40, 0x918000
    v_and_b32 v3, 15, v1
    v_lshl_add_u32 v217, v3, 7, s40
    s_lshl_b32 s41, s38, 7
    s_add_u32 s33, s40, s41
    v_mov_b32 v2, 0x90c000
    buffer_load_dword v216, v2, s[16:19], 0 offen sc1
    v_and_b32 v2, 7, v1
    v_bfe_u32 v3, v1, 3, 2
    v_lshrrev_b32 v4, 5, v1
    v_xor_b32 v4, v4, v2
    v_lshrrev_b32 v5, 1, v3
    v_xor_b32 v4, v4, v5
    v_lshlrev_b32 v4, 4, v4
    v_lshl_add_u32 v4, v2, 7, v4
    v_lshl_add_u32 v4, v3, 10, v4
    v_add_u32 v200, s49, v4
    v_xor_b32 v201, 32, v200
    v_xor_b32 v202, 64, v200
    v_xor_b32 v203, 96, v200
    v_xor_b32 v204, 0x1000, v200
    v_xor_b32 v205, 0x1000, v201
    v_xor_b32 v206, 0x1000, v202
    v_xor_b32 v207, 0x1000, v203
    v_bfe_u32 v2, v1, 2, 2
    v_and_b32 v3, 3, v1
    v_lshlrev_b32 v3, 3, v3
    v_and_b32 v4, 16, v1
    v_lshl_add_u32 v3, v4, 1, v3
    v_lshrrev_b32 v4, 5, v1
    v_lshl_add_u32 v4, v4, 3, v2
    s_mul_i32 s40, s47, 56
    s_lshl_b32 s41, s40, 1
    s_cmp_lt_u32 s39, 2
    s_cselect_b32 s41, s41, s40
    s_cselect_b32 s40, 56, 0x80
    s_add_u32 s40, s40, s41
    v_lshl_add_u32 v5, v2, 6, v3
    v_add_u32 v208, s41, v5
    v_and_b32 v208, 0xff, v208
    v_lshl_add_u32 v208, v4, 8, v208
    v_add_u32 v208, 16384, v208
    v_add_u32 v209, s40, v5
    v_and_b32 v209, 0xff, v209
    v_lshl_add_u32 v209, v4, 8, v209
    v_add_u32 v209, 16384, v209
    v_lshlrev_b32 v5, 5, v2
    v_and_b32 v5, 64, v5
    v_add_u32 v5, v5, v3
    v_lshl_add_u32 v5, v4, 7, v5
    v_add_u32 v210, 65536, v5
    v_xor_b32 v227, 64, v210
    s_lshl_b32 s40, s44, 7
    s_add_u32 m0, s49, 32768
    s_add_u32 s40, s40, s45
    buffer_load_dwordx4 v218, s[4:7], s40 offen offset:0 lds
    s_add_u32 s40, s40, 6144
    buffer_load_dwordx4 v218, s[4:7], s40 offen offset:1024 lds
    s_add_u32 s40, s40, 6144
    buffer_load_dwordx4 v219, s[4:7], s40 offen offset:2048 lds
    s_add_u32 s40, s40, 6144
    buffer_load_dwordx4 v219, s[4:7], s40 offen offset:3072 lds
    s_mul_i32 s41, s44, 172032
    s_add_u32 m0, s50, 32768
    s_add_u32 s41, s41, s46
    buffer_load_dwordx4 v220, s[8:11], s41 offen offset:0 lds
    s_add_u32 s41, s41, 9728
    buffer_load_dwordx4 v220, s[8:11], s41 offen offset:1024 lds
    s_add_u32 s41, s41, 9728
    buffer_load_dwordx4 v220, s[8:11], s41 offen offset:2048 lds
    s_add_u32 s41, s41, 9728
    buffer_load_dwordx4 v220, s[8:11], s41 offen offset:3072 lds
    s_add_u32 s44, s44, 1
    s_cmp_eq_u32 s44, 7
    s_cselect_b32 s44, 0, s44
    s_cmp_lt_u32 s3, 64
    s_cselect_b32 s76, s24, s58
    s_cselect_b32 s77, s25, s59
    s_and_b32 s40, s3, 63
    s_mul_i32 s40, s40, 49
    v_min_u32 v17, 12, v1
    v_add_lshl_u32 v17, v17, s40, 7
    s_lshl_b32 s40, s43, 1
    s_add_u32 s40, s40, s47
    s_lshl_b32 s40, s40, 5
    s_add_u32 s40, s40, s38
    s_lshl_b32 s40, s40, 2
    s_add_u32 s40, s40, s36
    s_lshl_b32 s56, s40, 12
    s_xor_b32 s57, s56, 0x1000
    s_lshl_b32 s40, s43, 1
    s_and_b32 s41, s39, 1
    s_add_u32 s40, s40, s41
    s_lshl_b32 s41, s40, 4
    s_add_u32 s41, s41, s38
    s_lshl_b32 s41, s41, 7
    s_lshl_b32 s42, s51, 14
    s_add_u32 s41, s41, s42
    s_add_u32 s55, s41, 0x910000
    s_lshl_b32 s40, s40, 1
    s_add_u32 s40, s40, s47
    s_lshl_b32 s40, s40, 1
    s_add_u32 s40, s40, s48
    s_lshl_b32 s40, s40, 5
    s_add_u32 s40, s40, s38
    s_lshl_b32 s40, s40, 10
    s_add_u32 s40, s40, 0x800000
    s_add_u32 s41, s40, 16384
    s_cmp_eq_u32 s51, 1
    s_cselect_b32 s56, s40, s56
    s_cselect_b32 s57, s41, s57
    s_lshl_b32 s40, s36, 11
    v_add_u32 v11, s40, v6
    v_add_u32 v222, 131072, v11
    v_xor_b32 v223, 0x1000, v222
    s_add_u32 s41, s36, 1
    s_and_b32 s41, s41, 3
    s_mul_i32 s72, s41, 12288
    s_lshl_b32 s41, s41, 11
    v_add_u32 v224, s41, v6
    s_add_u32 s41, s36, 2
    s_and_b32 s41, s41, 3
    s_mul_i32 s73, s41, 12288
    s_lshl_b32 s41, s41, 11
    v_add_u32 v225, s41, v6
    s_add_u32 s41, s36, 3
    s_and_b32 s41, s41, 3
    s_mul_i32 s74, s41, 12288
    s_lshl_b32 s41, s41, 11
    v_add_u32 v226, s41, v6
    s_lshl_b32 s40, s37, 2
    s_add_u32 s40, s40, s36
    s_lshl_b32 s41, s40, 16
    s_add_u32 s41, s41, 4096
    v_add_u32 v7, s41, v6
    s_lshl_b32 s41, s40, 14
    s_add_u32 s41, s41, 0x801000
    v_add_u32 v8, s41, v6
    s_lshl_b32 s40, s43, 3
    s_add_u32 s40, s40, s36
    s_lshl_b32 s40, s40, 9
    s_add_u32 s40, s40, 0x910000
    v_and_b32 v2, 3, v1
    v_and_b32 v3, 4, v1
    v_lshlrev_b32 v3, 9, v3
    v_lshl_add_u32 v2, v2, 7, v3
    v_add_u32 v14, s40, v2
    s_lshr_b32 s41, s37, 1
    s_lshl_b32 s41, s41, 11
    s_add_u32 s41, s41, 0x914000
    v_and_b32 v2, 15, v1
    v_lshl_add_u32 v15, v2, 7, s41
    s_lshl_b32 s40, s38, 2
    s_add_u32 s40, s40, s36
    s_lshl_b32 s40, s40, 4
    s_add_u32 s40, s40, s37
    s_lshl_b32 s41, s40, 7
    s_add_u32 s63, s41, 0x920000
    s_lshl_b32 s40, s40, 11
    s_add_u32 s61, s40, 0xa00000
    s_add_u32 s62, s40, 0xc00000
    s_lshl_b32 s40, s48, 10
    s_lshl_b32 s41, s47, 3
    s_add_u32 s40, s40, s41
    s_add_u32 s40, s40, 8192
    v_add_u32 v18, s40, v6
    s_mul_i32 s41, s36, 12288
    v_add_u32 v12, s41, v6
    s_lshr_b32 s58, s2, 3
    s_mul_i32 s40, s58, 37
    s_lshr_b32 s40, s40, 8
    s_mul_i32 s42, s40, 7
    s_sub_u32 s42, s58, s42
    s_min_u32 s40, s40, 3
    s_and_b32 s41, s2, 7
    s_lshl_b32 s41, s41, 2
    s_add_u32 s40, s40, s41
    s_lshl_b32 s40, s40, 1
    s_add_u32 s40, s40, s47
    s_mul_i32 s59, s40, 28672
    s_lshl_b32 s41, s42, 1
    s_add_u32 s41, s41, s48
    s_lshl_b32 s41, s41, 6
    s_add_u32 s59, s59, s41
    s_lshl_b32 s40, s40, 1
    s_add_u32 s40, s40, s48
    s_lshl_b32 s41, s40, 14
    s_add_u32 s41, s41, 0xc01000
    v_add_u32 v9, s41, v6
    s_lshl_b32 s41, s40, 10
    s_add_u32 s41, s41, 0x920000
    v_and_b32 v2, 7, v1
    v_lshl_add_u32 v16, v2, 7, s41
    v_and_b32 v2, 31, v1
    v_mul_u32_u24 v2, 896, v2
    v_lshrrev_b32 v3, 5, v1
    v_lshl_add_u32 v19, v3, 4, v2
    v_lshrrev_b32 v2, 3, v1
    v_mul_u32_u24 v2, 896, v2
    v_lshrrev_b32 v3, 2, v1
    v_and_b32 v3, 4, v3
    v_and_b32 v4, 7, v1
    v_xor_b32 v3, v3, v4
    v_lshl_add_u32 v2, v3, 4, v2
    s_lshl_b32 s40, s42, 7
    v_add_u32 v20, s40, v2
    v_add_u32 v21, 6144, v20
    v_add_u32 v22, 12288, v20
    v_add_u32 v23, 18432, v20
    s_mul_i32 s68, s36, 100352
    s_add_u32 s69, s68, 28672
    s_add_u32 s70, s68, 57344
    s_add_u32 s71, s68, 86016
    s_mul_i32 s60, s36, 14336
    v_and_b32 v3, 3, v1
    v_lshlrev_b32 v3, 3, v3
    v_and_b32 v2, 16, v1
    v_lshl_add_u32 v3, v2, 1, v3
    v_and_b32 v2, 8, v1
    v_lshl_add_u32 v3, v2, 3, v3
    s_lshl_b32 s40, s48, 6
    v_xor_b32 v3, s40, v3
    v_bfe_u32 v2, v1, 2, 2
    v_lshl_add_u32 v3, v2, 7, v3
    s_mul_i32 s40, s48, 28672
    s_add_u32 s40, s40, 106496
    v_add_u32 v28, s40, v3
    v_xor_b32 v29, 64, v28
    v_lshrrev_b32 v2, 5, v1
    v_lshl_add_u32 v26, v2, 9, v28
    v_xor_b32 v27, 64, v26
    v_subrev_u32 v24, 57344, v26
    v_subrev_u32 v25, 57344, v27
    v_mov_b32 v62, 0
    v_mov_b32 v238, 0
    v_mov_b32 v63, 0
    v_mov_b32 v239, 0
    s_mov_b32 s34, 0x07060100
    s_mov_b64 exec, 0
    s_cmp_eq_u32 s36, 0
    s_cbranch_scc1 L_f_pad0
    s_cmp_eq_u32 s36, 1
    s_cbranch_scc1 L_f_pad1
    s_cmp_eq_u32 s36, 2
    s_cbranch_scc1 L_f_pad2
    s_branch L_f_pad3
L_f_tdone:
    s_mov_b64 exec, -1
    s_cmp_lg_u32 s39, 0
    s_cbranch_scc1 L_f_N
    s_branch L_f_T
.p2align 12
L_f_T:
L_f_pad0:
    s_cbranch_execz L_f_pad4
    s_waitcnt vmcnt(8)
    v_readfirstlane_b32 s66, v216
    s_mov_b32 exec_lo, 0x80808080
    s_mov_b32 exec_hi, 0x80808080
    v_perm_b32 v230, v230, v211, s34
    s_mov_b64 exec, -1
    buffer_store_dwordx4 v[228:231], v214, s[16:19], 0 offen sc1
    s_add_u32 s67, s66, 0x9e3779b1
    s_barrier
    ds_read_b128 a[144:147], v200
    ds_read_b128 v[168:171], v204
    ds_read_b64_tr_b16 v[176:177], v208 offset:0
    ds_read_b64_tr_b16 v[178:179], v208 offset:1024
    ds_read_b64_tr_b16 v[180:181], v209 offset:0
    ds_read_b64_tr_b16 v[182:183], v209 offset:1024
    s_waitcnt lgkmcnt(0)
    v_mfma_f32_32x32x16_bf16 v[104:119], v[176:179], a[144:147], 0
    ds_read_b128 a[148:151], v201
    ds_read_b128 v[172:175], v205
    ds_read_b64_tr_b16 v[184:185], v208 offset:4096
    v_mov_b32 v103, 0x3f80
    v_mov_b32 v102, 0x3f803f80
    v_mfma_f32_32x32x16_bf16 v[136:151], v[176:179], v[168:171], 0
    ds_read_b64_tr_b16 v[186:187], v208 offset:5120
    ds_read_b64_tr_b16 v[188:189], v209 offset:4096
    ds_read_b64_tr_b16 v[190:191], v209 offset:5120
    s_lshl_b32 s40, s44, 7
    s_add_u32 m0, s49, 65536
    s_add_u32 s40, s40, s45
    buffer_load_dwordx4 v218, s[4:7], s40 offen offset:0 lds
    v_mov_b32 v55, 0x3f80
    v_mov_b32 v54, 0x3f803f80
    v_mfma_f32_32x32x16_bf16 v[120:135], v[180:183], a[144:147], 0
    s_add_u32 s40, s40, 6144
    buffer_load_dwordx4 v218, s[4:7], s40 offen offset:1024 lds
    v_mov_b32 v47, 0x3f80
    v_mov_b32 v46, 0x3f803f80
    v_mfma_f32_32x32x16_bf16 v[152:167], v[180:183], v[168:171], 0
    s_add_u32 s40, s40, 6144
    buffer_load_dwordx4 v219, s[4:7], s40 offen offset:2048 lds
    v_mov_b32 v39, 0x3f80
    v_mov_b32 v38, 0x3f803f80
    s_waitcnt lgkmcnt(0)
    v_mfma_f32_32x32x16_bf16 v[104:119], v[184:187], a[148:151], v[104:119]
    ds_read_b128 a[152:155], v202
    ds_read_b128 v[168:171], v206
    ds_read_b64_tr_b16 v[176:177], v208 offset:8192
    v_mfma_f32_32x32x16_bf16 v[136:151], v[184:187], v[172:175], v[136:151]
    ds_read_b64_tr_b16 v[178:179], v208 offset:9216
    ds_read_b64_tr_b16 v[180:181], v209 offset:8192
    ds_read_b64_tr_b16 v[182:183], v209 offset:9216
    s_add_u32 s40, s40, 6144
    buffer_load_dwordx4 v219, s[4:7], s40 offen offset:3072 lds
    v_mfma_f32_32x32x16_bf16 v[120:135], v[188:191], a[148:151], v[120:135]
    s_mul_i32 s41, s44, 172032
    s_add_u32 m0, s50, 65536
    s_add_u32 s41, s41, s46
    buffer_load_dwordx4 v220, s[8:11], s41 offen offset:0 lds
    v_mfma_f32_32x32x16_bf16 v[152:167], v[188:191], v[172:175], v[152:167]
    s_add_u32 s41, s41, 9728
    buffer_load_dwordx4 v220, s[8:11], s41 offen offset:1024 lds
    s_waitcnt lgkmcnt(0)
    v_mfma_f32_32x32x16_bf16 v[104:119], v[176:179], a[152:155], v[104:119]
    ds_read_b128 a[156:159], v203
    ds_read_b128 v[172:175], v207
    ds_read_b64_tr_b16 v[184:185], v208 offset:12288
    v_mfma_f32_32x32x16_bf16 v[136:151], v[176:179], v[168:171], v[136:151]
    ds_read_b64_tr_b16 v[186:187], v208 offset:13312
    ds_read_b64_tr_b16 v[188:189], v209 offset:12288
    ds_read_b64_tr_b16 v[190:191], v209 offset:13312
    s_add_u32 s41, s41, 9728
    buffer_load_dwordx4 v220, s[8:11], s41 offen offset:2048 lds
    v_mfma_f32_32x32x16_bf16 v[120:135], v[180:183], a[152:155], v[120:135]
    s_add_u32 s41, s41, 9728
    buffer_load_dwordx4 v220, s[8:11], s41 offen offset:3072 lds
    s_add_u32 s44, s44, 1
    s_cmp_eq_u32 s44, 7
    s_cselect_b32 s44, 0, s44
    v_mfma_f32_32x32x16_bf16 v[152:167], v[180:183], v[168:171], v[152:167]
    s_waitcnt lgkmcnt(0)
    v_mfma_f32_32x32x16_bf16 v[104:119], v[184:187], a[156:159], v[104:119]
    s_waitcnt vmcnt(9)
    s_barrier
    v_add_u32 v200, 0x8000, v200
    v_add_u32 v204, 0x8000, v204
    v_add_u32 v208, 0x8000, v208
    v_add_u32 v209, 0x8000, v209
    v_mfma_f32_32x32x16_bf16 v[136:151], v[184:187], v[172:175], v[136:151]
    ds_read_b128 a[160:163], v200
    ds_read_b128 v[168:171], v204
    ds_read_b64_tr_b16 v[176:177], v208 offset:0
    ds_read_b64_tr_b16 v[178:179], v208 offset:1024
    ds_read_b64_tr_b16 v[180:181], v209 offset:0
    ds_read_b64_tr_b16 v[182:183], v209 offset:1024
    v_mfma_f32_32x32x16_bf16 v[120:135], v[188:191], a[156:159], v[120:135]
    v_add_u32 v201, 0x8000, v201
    v_add_u32 v205, 0x8000, v205
    v_add_u32 v202, 0x8000, v202
    v_add_u32 v206, 0x8000, v206
    v_add_u32 v203, 0x8000, v203
    v_add_u32 v207, 0x8000, v207
    v_mfma_f32_32x32x16_bf16 v[152:167], v[188:191], v[172:175], v[152:167]
    s_waitcnt lgkmcnt(0)
    v_mfma_f32_32x32x16_bf16 v[104:119], v[176:179], a[160:163], v[104:119]
    ds_read_b128 a[164:167], v201
    ds_read_b128 v[172:175], v205
    ds_read_b64_tr_b16 v[184:185], v208 offset:4096
    v_mfma_f32_32x32x16_bf16 v[136:151], v[176:179], v[168:171], v[136:151]
    ds_read_b64_tr_b16 v[186:187], v208 offset:5120
    ds_read_b64_tr_b16 v[188:189], v209 offset:4096
    ds_read_b64_tr_b16 v[190:191], v209 offset:5120
    s_lshl_b32 s40, s44, 7
    s_add_u32 m0, s49, 98304
    s_add_u32 s40, s40, s45
    buffer_load_dwordx4 v218, s[4:7], s40 offen offset:0 lds
    v_mfma_f32_32x32x16_bf16 v[120:135], v[180:183], a[160:163], v[120:135]
    s_add_u32 s40, s40, 6144
    buffer_load_dwordx4 v218, s[4:7], s40 offen offset:1024 lds
    v_mfma_f32_32x32x16_bf16 v[152:167], v[180:183], v[168:171], v[152:167]
    s_add_u32 s40, s40, 6144
    buffer_load_dwordx4 v219, s[4:7], s40 offen offset:2048 lds
    s_waitcnt lgkmcnt(0)
    v_mfma_f32_32x32x16_bf16 v[104:119], v[184:187], a[164:167], v[104:119]
    ds_read_b128 a[168:171], v202
    ds_read_b128 v[168:171], v206
    ds_read_b64_tr_b16 v[176:177], v208 offset:8192
    v_mfma_f32_32x32x16_bf16 v[136:151], v[184:187], v[172:175], v[136:151]
    ds_read_b64_tr_b16 v[178:179], v208 offset:9216
    ds_read_b64_tr_b16 v[180:181], v209 offset:8192
    ds_read_b64_tr_b16 v[182:183], v209 offset:9216
    s_add_u32 s40, s40, 6144
    buffer_load_dwordx4 v219, s[4:7], s40 offen offset:3072 lds
    v_mfma_f32_32x32x16_bf16 v[120:135], v[188:191], a[164:167], v[120:135]
    s_mul_i32 s41, s44, 172032
    s_add_u32 m0, s50, 98304
    s_add_u32 s41, s41, s46
    buffer_load_dwordx4 v220, s[8:11], s41 offen offset:0 lds
    v_mfma_f32_32x32x16_bf16 v[152:167], v[188:191], v[172:175], v[152:167]
    s_add_u32 s41, s41, 9728
    buffer_load_dwordx4 v220, s[8:11], s41 offen offset:1024 lds
    s_waitcnt lgkmcnt(0)
    v_mfma_f32_32x32x16_bf16 v[104:119], v[176:179], a[168:171], v[104:119]
    ds_read_b128 a[172:175], v203
    ds_read_b128 v[172:175], v207
    ds_read_b64_tr_b16 v[184:185], v208 offset:12288
    v_mfma_f32_32x32x16_bf16 v[136:151], v[176:179], v[168:171], v[136:151]
    ds_read_b64_tr_b16 v[186:187], v208 offset:13312
    ds_read_b64_tr_b16 v[188:189], v209 offset:12288
    ds_read_b64_tr_b16 v[190:191], v209 offset:13312
    s_add_u32 s41, s41, 9728
    buffer_load_dwordx4 v220, s[8:11], s41 offen offset:2048 lds
    v_mfma_f32_32x32x16_bf16 v[120:135], v[180:183], a[168:171], v[120:135]
    s_add_u32 s41, s41, 9728
    buffer_load_dwordx4 v220, s[8:11], s41 offen offset:3072 lds
    s_add_u32 s44, s44, 1
    s_cmp_eq_u32 s44, 7
    s_cselect_b32 s44, 0, s44
    v_mfma_f32_32x32x16_bf16 v[152:167], v[180:183], v[168:171], v[152:167]
    s_waitcnt lgkmcnt(0)
    v_mfma_f32_32x32x16_bf16 v[104:119], v[184:187], a[172:175], v[104:119]
    s_waitcnt vmcnt(8)
    s_barrier
    v_add_u32 v200, 0x8000, v200
    v_add_u32 v204, 0x8000, v204
    v_add_u32 v208, 0x8000, v208
    v_add_u32 v209, 0x8000, v209
    v_mfma_f32_32x32x16_bf16 v[136:151], v[184:187], v[172:175], v[136:151]
    ds_read_b128 a[176:179], v200
    ds_read_b128 v[168:171], v204
    ds_read_b64_tr_b16 v[176:177], v208 offset:0
    ds_read_b64_tr_b16 v[178:179], v208 offset:1024
    ds_read_b64_tr_b16 v[180:181], v209 offset:0
    ds_read_b64_tr_b16 v[182:183], v209 offset:1024
    v_mfma_f32_32x32x16_bf16 v[120:135], v[188:191], a[172:175], v[120:135]
    v_add_u32 v201, 0x8000, v201
    v_add_u32 v205, 0x8000, v205
    v_add_u32 v202, 0x8000, v202
    v_add_u32 v206, 0x8000, v206
    v_add_u32 v203, 0x8000, v203
    v_add_u32 v207, 0x8000, v207
    v_mfma_f32_32x32x16_bf16 v[152:167], v[188:191], v[172:175], v[152:167]
    s_cmp_lg_u32 s36, 0
    s_cbranch_scc1 L_f_q0T
    v_lshlrev_b32 v2, 2, v1
    v_mov_b32 v3, s67
    s_mov_b64 exec, 0xffffffff
    buffer_store_dword v3, v2, s[16:19], s33 offen sc1
    s_mov_b64 exec, -1
    s_branch L_f_q1T
L_f_q0T:
    buffer_load_dword v216, v14, s[4:7], 0 offen
L_f_q1T:
    s_waitcnt lgkmcnt(0)
    v_mfma_f32_32x32x16_bf16 v[104:119], v[176:179], a[176:179], v[104:119]
    ds_read_b128 a[180:183], v201
    ds_read_b128 v[172:175], v205
    ds_read_b64_tr_b16 v[184:185], v208 offset:4096
    v_mfma_f32_32x32x16_bf16 v[136:151], v[176:179], v[168:171], v[136:151]
    ds_read_b64_tr_b16 v[186:187], v208 offset:5120
    ds_read_b64_tr_b16 v[188:189], v209 offset:4096
    ds_read_b64_tr_b16 v[190:191], v209 offset:5120
    s_lshl_b32 s40, s44, 7
    s_add_u32 m0, s49, 131072
    s_add_u32 s40, s40, s45
    buffer_load_dwordx4 v218, s[4:7], s40 offen offset:0 lds
    v_mfma_f32_32x32x16_bf16 v[120:135], v[180:183], a[176:179], v[120:135]
    s_add_u32 s40, s40, 6144
    buffer_load_dwordx4 v218, s[4:7], s40 offen offset:1024 lds
    v_mfma_f32_32x32x16_bf16 v[152:167], v[180:183], v[168:171], v[152:167]
    s_add_u32 s40, s40, 6144
    buffer_load_dwordx4 v219, s[4:7], s40 offen offset:2048 lds
    s_waitcnt lgkmcnt(0)
    v_mfma_f32_32x32x16_bf16 v[104:119], v[184:187], a[180:183], v[104:119]
    ds_read_b128 a[184:187], v202
    ds_read_b128 v[168:171], v206
    ds_read_b64_tr_b16 v[176:177], v208 offset:8192
    v_mfma_f32_32x32x16_bf16 v[136:151], v[184:187], v[172:175], v[136:151]
    ds_read_b64_tr_b16 v[178:179], v208 offset:9216
    ds_read_b64_tr_b16 v[180:181], v209 offset:8192
    ds_read_b64_tr_b16 v[182:183], v209 offset:9216
    s_add_u32 s40, s40, 6144
    buffer_load_dwordx4 v219, s[4:7], s40 offen offset:3072 lds
    v_mfma_f32_32x32x16_bf16 v[120:135], v[188:191], a[180:183], v[120:135]
    s_mul_i32 s41, s44, 172032
    s_add_u32 m0, s50, 131072
    s_add_u32 s41, s41, s46
    buffer_load_dwordx4 v220, s[8:11], s41 offen offset:0 lds
    v_mfma_f32_32x32x16_bf16 v[152:167], v[188:191], v[172:175], v[152:167]
    s_add_u32 s41, s41, 9728
    buffer_load_dwordx4 v220, s[8:11], s41 offen offset:1024 lds
    s_waitcnt lgkmcnt(0)
    v_mfma_f32_32x32x16_bf16 v[104:119], v[176:179], a[184:187], v[104:119]
    ds_read_b128 a[188:191], v203
    ds_read_b128 v[172:175], v207
    ds_read_b64_tr_b16 v[184:185], v208 offset:12288
    v_mfma_f32_32x32x16_bf16 v[136:151], v[176:179], v[168:171], v[136:151]
    ds_read_b64_tr_b16 v[186:187], v208 offset:13312
    ds_read_b64_tr_b16 v[188:189], v209 offset:12288
    ds_read_b64_tr_b16 v[190:191], v209 offset:13312
    s_add_u32 s41, s41, 9728
    buffer_load_dwordx4 v220, s[8:11], s41 offen offset:2048 lds
    v_mfma_f32_32x32x16_bf16 v[120:135], v[180:183], a[184:187], v[120:135]
    s_add_u32 s41, s41, 9728
    buffer_load_dwordx4 v220, s[8:11], s41 offen offset:3072 lds
    s_add_u32 s44, s44, 1
    s_cmp_eq_u32 s44, 7
    s_cselect_b32 s44, 0, s44
    v_mfma_f32_32x32x16_bf16 v[152:167], v[180:183], v[168:171], v[152:167]
    s_waitcnt lgkmcnt(0)
    v_mfma_f32_32x32x16_bf16 v[104:119], v[184:187], a[188:191], v[104:119]
    s_waitcnt vmcnt(9)
    s_barrier
    v_add_u32 v200, 0x8000, v200
    v_add_u32 v204, 0x8000, v204
    v_add_u32 v208, 0x8000, v208
    v_add_u32 v209, 0x8000, v209
    v_mfma_f32_32x32x16_bf16 v[136:151], v[184:187], v[172:175], v[136:151]
    ds_read_b128 a[192:195], v200
    ds_read_b128 v[168:171], v204
    ds_read_b64_tr_b16 v[176:177], v208 offset:0
    ds_read_b64_tr_b16 v[178:179], v208 offset:1024
    ds_read_b64_tr_b16 v[180:181], v209 offset:0
    ds_read_b64_tr_b16 v[182:183], v209 offset:1024
    v_mfma_f32_32x32x16_bf16 v[120:135], v[188:191], a[188:191], v[120:135]
    v_add_u32 v201, 0x8000, v201
    v_add_u32 v205, 0x8000, v205
    v_add_u32 v202, 0x8000, v202
    v_add_u32 v206, 0x8000, v206
    v_add_u32 v203, 0x8000, v203
    v_add_u32 v207, 0x8000, v207
    v_mfma_f32_32x32x16_bf16 v[152:167], v[188:191], v[172:175], v[152:167]
    s_waitcnt lgkmcnt(0)
    v_mfma_f32_32x32x16_bf16 v[104:119], v[176:179], a[192:195], v[104:119]
    ds_read_b128 a[196:199], v201
    ds_read_b128 v[172:175], v205
    ds_read_b64_tr_b16 v[184:185], v208 offset:4096
    v_mfma_f32_32x32x16_bf16 v[136:151], v[176:179], v[168:171], v[136:151]
    ds_read_b64_tr_b16 v[186:187], v208 offset:5120
    ds_read_b64_tr_b16 v[188:189], v209 offset:4096
    ds_read_b64_tr_b16 v[190:191], v209 offset:5120
    s_lshl_b32 s40, s44, 7
    s_add_u32 m0, s49, 0
    s_add_u32 s40, s40, s45
    buffer_load_dwordx4 v218, s[4:7], s40 offen offset:0 lds
    v_mfma_f32_32x32x16_bf16 v[120:135], v[180:183], a[192:195], v[120:135]
    s_add_u32 s40, s40, 6144
    buffer_load_dwordx4 v218, s[4:7], s40 offen offset:1024 lds
    v_mfma_f32_32x32x16_bf16 v[152:167], v[180:183], v[168:171], v[152:167]
    s_add_u32 s40, s40, 6144
    buffer_load_dwordx4 v219, s[4:7], s40 offen offset:2048 lds
    s_waitcnt lgkmcnt(0)
    v_mfma_f32_32x32x16_bf16 v[104:119], v[184:187], a[196:199], v[104:119]
    ds_read_b128 a[200:203], v202
    ds_read_b128 v[168:171], v206
    ds_read_b64_tr_b16 v[176:177], v208 offset:8192
    v_mfma_f32_32x32x16_bf16 v[136:151], v[184:187], v[172:175], v[136:151]
    ds_read_b64_tr_b16 v[178:179], v208 offset:9216
    ds_read_b64_tr_b16 v[180:181], v209 offset:8192
    ds_read_b64_tr_b16 v[182:183], v209 offset:9216
    s_add_u32 s40, s40, 6144
    buffer_load_dwordx4 v219, s[4:7], s40 offen offset:3072 lds
    v_mfma_f32_32x32x16_bf16 v[120:135], v[188:191], a[196:199], v[120:135]
    s_mul_i32 s41, s44, 172032
    s_add_u32 m0, s50, 0
    s_add_u32 s41, s41, s46
    buffer_load_dwordx4 v220, s[8:11], s41 offen offset:0 lds
    v_mfma_f32_32x32x16_bf16 v[152:167], v[188:191], v[172:175], v[152:167]
    s_add_u32 s41, s41, 9728
    buffer_load_dwordx4 v220, s[8:11], s41 offen offset:1024 lds
    s_waitcnt lgkmcnt(0)
    v_mfma_f32_32x32x16_bf16 v[104:119], v[176:179], a[200:203], v[104:119]
    ds_read_b128 a[204:207], v203
    ds_read_b128 v[172:175], v207
    ds_read_b64_tr_b16 v[184:185], v208 offset:12288
    v_mfma_f32_32x32x16_bf16 v[136:151], v[176:179], v[168:171], v[136:151]
    ds_read_b64_tr_b16 v[186:187], v208 offset:13312
    ds_read_b64_tr_b16 v[188:189], v209 offset:12288
    ds_read_b64_tr_b16 v[190:191], v209 offset:13312
    s_add_u32 s41, s41, 9728
    buffer_load_dwordx4 v220, s[8:11], s41 offen offset:2048 lds
    v_mfma_f32_32x32x16_bf16 v[120:135], v[180:183], a[200:203], v[120:135]
    s_add_u32 s41, s41, 9728
    buffer_load_dwordx4 v220, s[8:11], s41 offen offset:3072 lds
    s_add_u32 s44, s44, 1
    s_cmp_eq_u32 s44, 7
    s_cselect_b32 s44, 0, s44
    v_mfma_f32_32x32x16_bf16 v[152:167], v[180:183], v[168:171], v[152:167]
    s_waitcnt lgkmcnt(0)
    v_mfma_f32_32x32x16_bf16 v[104:119], v[184:187], a[204:207], v[104:119]
    s_waitcnt vmcnt(8)
    s_barrier
    v_add_u32 v200, 0x8000, v200
    v_add_u32 v204, 0x8000, v204
    v_add_u32 v208, 0x8000, v208
    v_add_u32 v209, 0x8000, v209
    v_mfma_f32_32x32x16_bf16 v[136:151], v[184:187], v[172:175], v[136:151]
    ds_read_b128 a[208:211], v200
    ds_read_b128 v[168:171], v204
    ds_read_b64_tr_b16 v[176:177], v208 offset:0
    ds_read_b64_tr_b16 v[178:179], v208 offset:1024
    ds_read_b64_tr_b16 v[180:181], v209 offset:0
    ds_read_b64_tr_b16 v[182:183], v209 offset:1024
    v_mfma_f32_32x32x16_bf16 v[120:135], v[188:191], a[204:207], v[120:135]
    v_add_u32 v201, 0x8000, v201
    v_add_u32 v205, 0x8000, v205
    v_add_u32 v202, 0x8000, v202
    v_add_u32 v206, 0x8000, v206
    v_add_u32 v203, 0x8000, v203
    v_add_u32 v207, 0x8000, v207
    v_mfma_f32_32x32x16_bf16 v[152:167], v[188:191], v[172:175], v[152:167]
    s_waitcnt lgkmcnt(0)
    v_mfma_f32_32x32x16_bf16 v[104:119], v[176:179], a[208:211], v[104:119]
    ds_read_b128 a[212:215], v201
    ds_read_b128 v[172:175], v205
    ds_read_b64_tr_b16 v[184:185], v208 offset:4096
    v_mfma_f32_32x32x16_bf16 v[136:151], v[176:179], v[168:171], v[136:151]
    ds_read_b64_tr_b16 v[186:187], v208 offset:5120
    ds_read_b64_tr_b16 v[188:189], v209 offset:4096
    ds_read_b64_tr_b16 v[190:191], v209 offset:5120
    s_lshl_b32 s40, s44, 7
    s_add_u32 m0, s49, 32768
    s_add_u32 s40, s40, s45
    buffer_load_dwordx4 v218, s[4:7], s40 offen offset:0 lds
    v_mfma_f32_32x32x16_bf16 v[120:135], v[180:183], a[208:211], v[120:135]
    s_add_u32 s40, s40, 6144
    buffer_load_dwordx4 v218, s[4:7], s40 offen offset:1024 lds
    v_mfma_f32_32x32x16_bf16 v[152:167], v[180:183], v[168:171], v[152:167]
    s_add_u32 s40, s40, 6144
    buffer_load_dwordx4 v219, s[4:7], s40 offen offset:2048 lds
    s_waitcnt lgkmcnt(0)
    v_mfma_f32_32x32x16_bf16 v[104:119], v[184:187], a[212:215], v[104:119]
    ds_read_b128 a[216:219], v202
    ds_read_b128 v[168:171], v206
    ds_read_b64_tr_b16 v[176:177], v208 offset:8192
    v_mfma_f32_32x32x16_bf16 v[136:151], v[184:187], v[172:175], v[136:151]
    ds_read_b64_tr_b16 v[178:179], v208 offset:9216
    ds_read_b64_tr_b16 v[180:181], v209 offset:8192
    ds_read_b64_tr_b16 v[182:183], v209 offset:9216
    s_add_u32 s40, s40, 6144
    buffer_load_dwordx4 v219, s[4:7], s40 offen offset:3072 lds
    v_mfma_f32_32x32x16_bf16 v[120:135], v[188:191], a[212:215], v[120:135]
    s_mul_i32 s41, s44, 172032
    s_add_u32 m0, s50, 32768
    s_add_u32 s41, s41, s46
    buffer_load_dwordx4 v220, s[8:11], s41 offen offset:0 lds
    v_mfma_f32_32x32x16_bf16 v[152:167], v[188:191], v[172:175], v[152:167]
    s_add_u32 s41, s41, 9728
    buffer_load_dwordx4 v220, s[8:11], s41 offen offset:1024 lds
    s_waitcnt lgkmcnt(0)
    v_mfma_f32_32x32x16_bf16 v[104:119], v[176:179], a[216:219], v[104:119]
    ds_read_b128 a[220:223], v203
    ds_read_b128 v[172:175], v207
    ds_read_b64_tr_b16 v[184:185], v208 offset:12288
    v_mfma_f32_32x32x16_bf16 v[136:151], v[176:179], v[168:171], v[136:151]
    ds_read_b64_tr_b16 v[186:187], v208 offset:13312
    ds_read_b64_tr_b16 v[188:189], v209 offset:12288
    ds_read_b64_tr_b16 v[190:191], v209 offset:13312
    s_add_u32 s41, s41, 9728
    buffer_load_dwordx4 v220, s[8:11], s41 offen offset:2048 lds
    v_mfma_f32_32x32x16_bf16 v[120:135], v[180:183], a[216:219], v[120:135]
    s_add_u32 s41, s41, 9728
    buffer_load_dwordx4 v220, s[8:11], s41 offen offset:3072 lds
    s_add_u32 s44, s44, 1
    s_cmp_eq_u32 s44, 7
    s_cselect_b32 s44, 0, s44
    v_mfma_f32_32x32x16_bf16 v[152:167], v[180:183], v[168:171], v[152:167]
    s_waitcnt lgkmcnt(0)
    v_mfma_f32_32x32x16_bf16 v[104:119], v[184:187], a[220:223], v[104:119]
    s_waitcnt vmcnt(8)
    s_barrier
    v_add_u32 v200, 0xfffe0000, v200
    v_add_u32 v204, 0xfffe0000, v204
    v_add_u32 v208, 0xfffe0000, v208
    v_add_u32 v209, 0xfffe0000, v209
    v_mfma_f32_32x32x16_bf16 v[136:151], v[184:187], v[172:175], v[136:151]
    ds_read_b128 a[224:227], v200
    ds_read_b128 v[168:171], v204
    ds_read_b64_tr_b16 v[176:177], v208 offset:0
    ds_read_b64_tr_b16 v[178:179], v208 offset:1024
    ds_read_b64_tr_b16 v[180:181], v209 offset:0
    ds_read_b64_tr_b16 v[182:183], v209 offset:1024
    v_mfma_f32_32x32x16_bf16 v[120:135], v[188:191], a[220:223], v[120:135]
    v_add_u32 v201, 0xfffe0000, v201
    v_add_u32 v205, 0xfffe0000, v205
    v_add_u32 v202, 0xfffe0000, v202
    v_add_u32 v206, 0xfffe0000, v206
    v_add_u32 v203, 0xfffe0000, v203
    v_add_u32 v207, 0xfffe0000, v207
    v_mfma_f32_32x32x16_bf16 v[152:167], v[188:191], v[172:175], v[152:167]
    s_waitcnt lgkmcnt(0)
    v_mfma_f32_32x32x16_bf16 v[104:119], v[176:179], a[224:227], v[104:119]
    ds_read_b128 a[228:231], v201
    ds_read_b128 v[172:175], v205
    ds_read_b64_tr_b16 v[184:185], v208 offset:4096
    v_mfma_f32_32x32x16_bf16 v[136:151], v[176:179], v[168:171], v[136:151]
    ds_read_b64_tr_b16 v[186:187], v208 offset:5120
    ds_read_b64_tr_b16 v[188:189], v209 offset:4096
    ds_read_b64_tr_b16 v[190:191], v209 offset:5120
    v_mfma_f32_32x32x16_bf16 v[120:135], v[180:183], a[224:227], v[120:135]
    v_mfma_f32_32x32x16_bf16 v[152:167], v[180:183], v[168:171], v[152:167]
    s_waitcnt lgkmcnt(0)
    v_mfma_f32_32x32x16_bf16 v[104:119], v[184:187], a[228:231], v[104:119]
    ds_read_b128 a[232:235], v202
    ds_read_b128 v[168:171], v206
    ds_read_b64_tr_b16 v[176:177], v208 offset:8192
    v_mfma_f32_32x32x16_bf16 v[136:151], v[184:187], v[172:175], v[136:151]
    ds_read_b64_tr_b16 v[178:179], v208 offset:9216
    ds_read_b64_tr_b16 v[180:181], v209 offset:8192
    ds_read_b64_tr_b16 v[182:183], v209 offset:9216
    v_mfma_f32_32x32x16_bf16 v[120:135], v[188:191], a[228:231], v[120:135]
    v_mfma_f32_32x32x16_bf16 v[152:167], v[188:191], v[172:175], v[152:167]
    s_waitcnt lgkmcnt(0)
    v_mfma_f32_32x32x16_bf16 v[104:119], v[176:179], a[232:235], v[104:119]
    ds_read_b128 a[236:239], v203
    ds_read_b128 v[172:175], v207
    ds_read_b64_tr_b16 v[184:185], v208 offset:12288
    v_mfma_f32_32x32x16_bf16 v[136:151], v[176:179], v[168:171], v[136:151]
    ds_read_b64_tr_b16 v[186:187], v208 offset:13312
    ds_read_b64_tr_b16 v[188:189], v209 offset:12288
    ds_read_b64_tr_b16 v[190:191], v209 offset:13312
    v_mfma_f32_32x32x16_bf16 v[120:135], v[180:183], a[232:235], v[120:135]
    v_mfma_f32_32x32x16_bf16 v[152:167], v[180:183], v[168:171], v[152:167]
    buffer_load_dword v13, v217, s[16:19], 0 offen sc1
    s_waitcnt lgkmcnt(0)
    v_mfma_f32_32x32x16_bf16 v[104:119], v[184:187], a[236:239], v[104:119]
    s_waitcnt vmcnt(1)
    s_barrier
    v_add_u32 v200, 0x8000, v200
    v_add_u32 v204, 0x8000, v204
    v_add_u32 v208, 0x8000, v208
    v_add_u32 v209, 0x8000, v209
    v_mfma_f32_32x32x16_bf16 v[136:151], v[184:187], v[172:175], v[136:151]
    ds_read_b128 a[240:243], v200
    ds_read_b128 v[168:171], v204
    ds_read_b64_tr_b16 v[176:177], v208 offset:0
    ds_read_b64_tr_b16 v[178:179], v208 offset:1024
    ds_read_b64_tr_b16 v[180:181], v209 offset:0
    ds_read_b64_tr_b16 v[182:183], v209 offset:1024
    v_mfma_f32_32x32x16_bf16 v[120:135], v[188:191], a[236:239], v[120:135]
    v_add_u32 v201, 0x8000, v201
    v_add_u32 v205, 0x8000, v205
    v_add_u32 v202, 0x8000, v202
    v_add_u32 v206, 0x8000, v206
    v_add_u32 v203, 0x8000, v203
    v_add_u32 v207, 0x8000, v207
    v_mfma_f32_32x32x16_bf16 v[152:167], v[188:191], v[172:175], v[152:167]
    s_waitcnt lgkmcnt(0)
    v_mfma_f32_32x32x16_bf16 v[104:119], v[176:179], a[240:243], v[104:119]
    ds_read_b128 a[244:247], v201
    ds_read_b128 v[172:175], v205
    ds_read_b64_tr_b16 v[184:185], v208 offset:4096
    v_mfma_f32_32x32x16_bf16 v[136:151], v[176:179], v[168:171], v[136:151]
    ds_read_b64_tr_b16 v[186:187], v208 offset:5120
    ds_read_b64_tr_b16 v[188:189], v209 offset:4096
    ds_read_b64_tr_b16 v[190:191], v209 offset:5120
    v_mfma_f32_32x32x16_bf16 v[120:135], v[180:183], a[240:243], v[120:135]
    v_mfma_f32_32x32x16_bf16 v[152:167], v[180:183], v[168:171], v[152:167]
    s_waitcnt lgkmcnt(0)
    v_mfma_f32_32x32x16_bf16 v[104:119], v[184:187], a[244:247], v[104:119]
    ds_read_b128 a[248:251], v202
    ds_read_b128 v[168:171], v206
    ds_read_b64_tr_b16 v[176:177], v208 offset:8192
    v_mfma_f32_32x32x16_bf16 v[136:151], v[184:187], v[172:175], v[136:151]
    ds_read_b64_tr_b16 v[178:179], v208 offset:9216
    ds_read_b64_tr_b16 v[180:181], v209 offset:8192
    ds_read_b64_tr_b16 v[182:183], v209 offset:9216
    v_mfma_f32_32x32x16_bf16 v[120:135], v[188:191], a[244:247], v[120:135]
    v_mfma_f32_32x32x16_bf16 v[152:167], v[188:191], v[172:175], v[152:167]
    s_waitcnt lgkmcnt(0)
    v_mfma_f32_32x32x16_bf16 v[104:119], v[176:179], a[248:251], v[104:119]
    ds_read_b128 a[252:255], v203
    ds_read_b128 v[172:175], v207
    ds_read_b64_tr_b16 v[184:185], v208 offset:12288
    v_mfma_f32_32x32x16_bf16 v[136:151], v[176:179], v[168:171], v[136:151]
    ds_read_b64_tr_b16 v[186:187], v208 offset:13312
    ds_read_b64_tr_b16 v[188:189], v209 offset:12288
    ds_read_b64_tr_b16 v[190:191], v209 offset:13312
    v_mfma_f32_32x32x16_bf16 v[120:135], v[180:183], a[248:251], v[120:135]
    v_mfma_f32_32x32x16_bf16 v[152:167], v[180:183], v[168:171], v[152:167]
    s_waitcnt lgkmcnt(0)
    v_mfma_f32_32x32x16_bf16 v[104:119], v[184:187], a[252:255], v[104:119]
    v_mfma_f32_32x32x16_bf16 v[136:151], v[184:187], v[172:175], v[136:151]
    v_mfma_f32_32x32x16_bf16 v[120:135], v[188:191], a[252:255], v[120:135]
    v_mfma_f32_32x32x16_bf16 v[152:167], v[188:191], v[172:175], v[152:167]
    s_nop 8
    v_cvt_pk_bf16_f32 v32, v104, v105
    v_cvt_pk_bf16_f32 v33, v106, v107
    v_cvt_pk_bf16_f32 v34, v108, v109
    v_cvt_pk_bf16_f32 v35, v110, v111
    v_cvt_pk_bf16_f32 v36, v112, v113
    v_cvt_pk_bf16_f32 v37, v114, v115
    s_mov_b64 exec, 0xffffffff
    v_cvt_pk_bf16_f32 v38, v116, v117
    v_cvt_pk_bf16_f32 v39, v118, v119
    s_mov_b64 exec, -1
    buffer_store_dwordx4 v[32:35], v6, s[16:19], s56 offen offset:0 sc1
    buffer_store_dwordx4 v[36:39], v6, s[16:19], s56 offen offset:1024 sc1
    s_add_u32 s56, s56, 262144
    v_cvt_pk_bf16_f32 v48, v136, v137
    v_cvt_pk_bf16_f32 v49, v138, v139
    v_cvt_pk_bf16_f32 v50, v140, v141
    v_cvt_pk_bf16_f32 v51, v142, v143
    v_cvt_pk_bf16_f32 v52, v144, v145
    v_cvt_pk_bf16_f32 v53, v146, v147
    s_mov_b64 exec, 0xffffffff
    v_cvt_pk_bf16_f32 v54, v148, v149
    v_cvt_pk_bf16_f32 v55, v150, v151
    s_mov_b64 exec, -1
    buffer_store_dwordx4 v[48:51], v6, s[16:19], s57 offen offset:0 sc1
    buffer_store_dwordx4 v[52:55], v6, s[16:19], s57 offen offset:1024 sc1
    s_add_u32 s57, s57, 262144
    v_cvt_pk_bf16_f32 v40, v120, v121
    v_cvt_pk_bf16_f32 v41, v122, v123
    v_cvt_pk_bf16_f32 v42, v124, v125
    v_cvt_pk_bf16_f32 v43, v126, v127
    v_cvt_pk_bf16_f32 v44, v128, v129
L_f_pad1:
    s_cbranch_execz L_f_pad5
    v_cvt_pk_bf16_f32 v45, v130, v131
    s_mov_b64 exec, 0xffffffff
    v_cvt_pk_bf16_f32 v46, v132, v133
    v_cvt_pk_bf16_f32 v47, v134, v135
    s_mov_b64 exec, -1
    buffer_store_dwordx4 v[40:43], v6, s[16:19], s56 offen offset:0 sc1
    buffer_store_dwordx4 v[44:47], v6, s[16:19], s56 offen offset:1024 sc1
    v_cvt_pk_bf16_f32 v96, v152, v153
    v_cvt_pk_bf16_f32 v97, v154, v155
    v_cvt_pk_bf16_f32 v98, v156, v157
    v_cvt_pk_bf16_f32 v99, v158, v159
    v_cvt_pk_bf16_f32 v100, v160, v161
    v_cvt_pk_bf16_f32 v101, v162, v163
    s_mov_b64 exec, 0xffffffff
    v_cvt_pk_bf16_f32 v102, v164, v165
    v_cvt_pk_bf16_f32 v103, v166, v167
    s_mov_b64 exec, -1
    buffer_store_dwordx4 v[96:99], v6, s[16:19], s57 offen offset:0 sc1
    buffer_store_dwordx4 v[100:103], v6, s[16:19], s57 offen offset:1024 sc1
    s_branch L_f_kvpub
.p2align 12
L_f_N:
L_f_pad2:
    s_cbranch_execz L_f_pad6
    s_cmp_eq_u32 s39, 1
    s_cselect_b32 s52, 0x3f803f80, 0
    s_waitcnt vmcnt(8)
    v_readfirstlane_b32 s66, v216
    s_mov_b32 exec_lo, 0x80808080
    s_mov_b32 exec_hi, 0x80808080
    v_perm_b32 v230, v230, v211, s34
    s_mov_b64 exec, -1
    buffer_store_dwordx4 v[228:231], v214, s[16:19], 0 offen sc1
    s_add_u32 s67, s66, 0x9e3779b1
    s_barrier
    ds_read_b128 a[144:147], v200
    ds_read_b128 v[168:171], v204
    ds_read_b64_tr_b16 v[176:177], v208 offset:0
    ds_read_b64_tr_b16 v[178:179], v208 offset:1024
    ds_read_b64_tr_b16 v[180:181], v209 offset:0
    ds_read_b64_tr_b16 v[182:183], v209 offset:1024
    s_waitcnt lgkmcnt(0)
    v_mfma_f32_32x32x16_bf16 v[104:119], a[144:147], v[176:179], 0
    ds_read_b128 a[148:151], v201
    ds_read_b128 v[172:175], v205
    ds_read_b64_tr_b16 v[184:185], v208 offset:4096
    v_mov_b32 v103, 0x3f803f80
    v_mov_b32 v102, 0x3f803f80
    v_mfma_f32_32x32x16_bf16 v[136:151], v[168:171], v[176:179], 0
    ds_read_b64_tr_b16 v[186:187], v208 offset:5120
    ds_read_b64_tr_b16 v[188:189], v209 offset:4096
    ds_read_b64_tr_b16 v[190:191], v209 offset:5120
    s_lshl_b32 s40, s44, 7
    s_add_u32 m0, s49, 65536
    s_add_u32 s40, s40, s45
    buffer_load_dwordx4 v218, s[4:7], s40 offen offset:0 lds
    v_mov_b32 v101, 0x3f803f80
    v_mov_b32 v100, 0x3f803f80
    v_mfma_f32_32x32x16_bf16 v[120:135], a[144:147], v[180:183], 0
    s_add_u32 s40, s40, 6144
    buffer_load_dwordx4 v218, s[4:7], s40 offen offset:1024 lds
    v_mov_b32 v99, 0x3f803f80
    v_mov_b32 v98, 0x3f803f80
    v_mfma_f32_32x32x16_bf16 v[152:167], v[168:171], v[180:183], 0
    s_add_u32 s40, s40, 6144
    buffer_load_dwordx4 v219, s[4:7], s40 offen offset:2048 lds
    v_mov_b32 v97, 0x3f803f80
    v_mov_b32 v96, 0x3f803f80
    s_waitcnt lgkmcnt(0)
    v_mfma_f32_32x32x16_bf16 v[104:119], a[148:151], v[184:187], v[104:119]
    ds_read_b128 a[152:155], v202
    ds_read_b128 v[168:171], v206
    ds_read_b64_tr_b16 v[176:177], v208 offset:8192
    v_mov_b32 v55, s52
    v_mov_b32 v54, s52
    v_mfma_f32_32x32x16_bf16 v[136:151], v[172:175], v[184:187], v[136:151]
    ds_read_b64_tr_b16 v[178:179], v208 offset:9216
    ds_read_b64_tr_b16 v[180:181], v209 offset:8192
    ds_read_b64_tr_b16 v[182:183], v209 offset:9216
    s_add_u32 s40, s40, 6144
    buffer_load_dwordx4 v219, s[4:7], s40 offen offset:3072 lds
    v_mov_b32 v53, s52
    v_mov_b32 v52, s52
    v_mfma_f32_32x32x16_bf16 v[120:135], a[148:151], v[188:191], v[120:135]
    s_mul_i32 s41, s44, 172032
    s_add_u32 m0, s50, 65536
    s_add_u32 s41, s41, s46
    buffer_load_dwordx4 v220, s[8:11], s41 offen offset:0 lds
    v_mov_b32 v51, s52
    v_mov_b32 v50, s52
    v_mfma_f32_32x32x16_bf16 v[152:167], v[172:175], v[188:191], v[152:167]
    s_add_u32 s41, s41, 9728
    buffer_load_dwordx4 v220, s[8:11], s41 offen offset:1024 lds
    v_mov_b32 v49, s52
    v_mov_b32 v48, s52
    s_waitcnt lgkmcnt(0)
    v_mfma_f32_32x32x16_bf16 v[104:119], a[152:155], v[176:179], v[104:119]
    ds_read_b128 a[156:159], v203
    ds_read_b128 v[172:175], v207
    ds_read_b64_tr_b16 v[184:185], v208 offset:12288
    v_mov_b32 v47, 0x3f803f80
    v_mov_b32 v46, 0x3f803f80
    v_mfma_f32_32x32x16_bf16 v[136:151], v[168:171], v[176:179], v[136:151]
    ds_read_b64_tr_b16 v[186:187], v208 offset:13312
    ds_read_b64_tr_b16 v[188:189], v209 offset:12288
    ds_read_b64_tr_b16 v[190:191], v209 offset:13312
    s_add_u32 s41, s41, 9728
    buffer_load_dwordx4 v220, s[8:11], s41 offen offset:2048 lds
    v_mov_b32 v45, 0x3f803f80
    v_mov_b32 v44, 0x3f803f80
    v_mfma_f32_32x32x16_bf16 v[120:135], a[152:155], v[180:183], v[120:135]
    s_add_u32 s41, s41, 9728
    buffer_load_dwordx4 v220, s[8:11], s41 offen offset:3072 lds
    s_add_u32 s44, s44, 1
    s_cmp_eq_u32 s44, 7
    s_cselect_b32 s44, 0, s44
    v_mov_b32 v43, 0x3f803f80
    v_mov_b32 v42, 0x3f803f80
    v_mfma_f32_32x32x16_bf16 v[152:167], v[168:171], v[180:183], v[152:167]
    v_mov_b32 v41, 0x3f803f80
    v_mov_b32 v40, 0x3f803f80
    s_waitcnt lgkmcnt(0)
    v_mfma_f32_32x32x16_bf16 v[104:119], a[156:159], v[184:187], v[104:119]
    s_waitcnt vmcnt(9)
    s_barrier
    v_add_u32 v200, 0x8000, v200
    v_add_u32 v204, 0x8000, v204
    v_add_u32 v208, 0x8000, v208
    v_add_u32 v209, 0x8000, v209
    v_mfma_f32_32x32x16_bf16 v[136:151], v[172:175], v[184:187], v[136:151]
    ds_read_b128 a[160:163], v200
    ds_read_b128 v[168:171], v204
    ds_read_b64_tr_b16 v[176:177], v208 offset:0
    ds_read_b64_tr_b16 v[178:179], v208 offset:1024
    ds_read_b64_tr_b16 v[180:181], v209 offset:0
    ds_read_b64_tr_b16 v[182:183], v209 offset:1024
    v_mfma_f32_32x32x16_bf16 v[120:135], a[156:159], v[188:191], v[120:135]
    v_add_u32 v201, 0x8000, v201
    v_add_u32 v205, 0x8000, v205
    v_add_u32 v202, 0x8000, v202
    v_add_u32 v206, 0x8000, v206
    v_add_u32 v203, 0x8000, v203
    v_add_u32 v207, 0x8000, v207
    v_mfma_f32_32x32x16_bf16 v[152:167], v[172:175], v[188:191], v[152:167]
    s_waitcnt lgkmcnt(0)
    v_mfma_f32_32x32x16_bf16 v[104:119], a[160:163], v[176:179], v[104:119]
    ds_read_b128 a[164:167], v201
    ds_read_b128 v[172:175], v205
    ds_read_b64_tr_b16 v[184:185], v208 offset:4096
    v_mov_b32 v39, s52
    v_mov_b32 v38, s52
    v_mfma_f32_32x32x16_bf16 v[136:151], v[168:171], v[176:179], v[136:151]
    ds_read_b64_tr_b16 v[186:187], v208 offset:5120
    ds_read_b64_tr_b16 v[188:189], v209 offset:4096
    ds_read_b64_tr_b16 v[190:191], v209 offset:5120
    s_lshl_b32 s40, s44, 7
    s_add_u32 m0, s49, 98304
    s_add_u32 s40, s40, s45
    buffer_load_dwordx4 v218, s[4:7], s40 offen offset:0 lds
    v_mov_b32 v37, s52
    v_mov_b32 v36, s52
    v_mfma_f32_32x32x16_bf16 v[120:135], a[160:163], v[180:183], v[120:135]
    s_add_u32 s40, s40, 6144
    buffer_load_dwordx4 v218, s[4:7], s40 offen offset:1024 lds
    v_mov_b32 v35, s52
    v_mov_b32 v34, s52
    v_mfma_f32_32x32x16_bf16 v[152:167], v[168:171], v[180:183], v[152:167]
    s_add_u32 s40, s40, 6144
    buffer_load_dwordx4 v219, s[4:7], s40 offen offset:2048 lds
    v_mov_b32 v33, s52
    v_mov_b32 v32, s52
    s_waitcnt lgkmcnt(0)
    v_mfma_f32_32x32x16_bf16 v[104:119], a[164:167], v[184:187], v[104:119]
    ds_read_b128 a[168:171], v202
    ds_read_b128 v[168:171], v206
    ds_read_b64_tr_b16 v[176:177], v208 offset:8192
    v_mfma_f32_32x32x16_bf16 v[136:151], v[172:175], v[184:187], v[136:151]
    ds_read_b64_tr_b16 v[178:179], v208 offset:9216
    ds_read_b64_tr_b16 v[180:181], v209 offset:8192
    ds_read_b64_tr_b16 v[182:183], v209 offset:9216
    s_add_u32 s40, s40, 6144
    buffer_load_dwordx4 v219, s[4:7], s40 offen offset:3072 lds
    v_mfma_f32_32x32x16_bf16 v[120:135], a[164:167], v[188:191], v[120:135]
    s_mul_i32 s41, s44, 172032
    s_add_u32 m0, s50, 98304
    s_add_u32 s41, s41, s46
    buffer_load_dwordx4 v220, s[8:11], s41 offen offset:0 lds
    v_mfma_f32_32x32x16_bf16 v[152:167], v[172:175], v[188:191], v[152:167]
    s_add_u32 s41, s41, 9728
    buffer_load_dwordx4 v220, s[8:11], s41 offen offset:1024 lds
    s_waitcnt lgkmcnt(0)
    v_mfma_f32_32x32x16_bf16 v[104:119], a[168:171], v[176:179], v[104:119]
    ds_read_b128 a[172:175], v203
    ds_read_b128 v[172:175], v207
    ds_read_b64_tr_b16 v[184:185], v208 offset:12288
    v_mfma_f32_32x32x16_bf16 v[136:151], v[168:171], v[176:179], v[136:151]
    ds_read_b64_tr_b16 v[186:187], v208 offset:13312
    ds_read_b64_tr_b16 v[188:189], v209 offset:12288
    ds_read_b64_tr_b16 v[190:191], v209 offset:13312
    s_add_u32 s41, s41, 9728
    buffer_load_dwordx4 v220, s[8:11], s41 offen offset:2048 lds
    v_mfma_f32_32x32x16_bf16 v[120:135], a[168:171], v[180:183], v[120:135]
    s_add_u32 s41, s41, 9728
    buffer_load_dwordx4 v220, s[8:11], s41 offen offset:3072 lds
    s_add_u32 s44, s44, 1
    s_cmp_eq_u32 s44, 7
    s_cselect_b32 s44, 0, s44
    v_mfma_f32_32x32x16_bf16 v[152:167], v[168:171], v[180:183], v[152:167]
    s_waitcnt lgkmcnt(0)
    v_mfma_f32_32x32x16_bf16 v[104:119], a[172:175], v[184:187], v[104:119]
    s_waitcnt vmcnt(8)
    s_barrier
    v_add_u32 v200, 0x8000, v200
    v_add_u32 v204, 0x8000, v204
    v_add_u32 v208, 0x8000, v208
    v_add_u32 v209, 0x8000, v209
    v_mfma_f32_32x32x16_bf16 v[136:151], v[172:175], v[184:187], v[136:151]
    ds_read_b128 a[176:179], v200
    ds_read_b128 v[168:171], v204
    ds_read_b64_tr_b16 v[176:177], v208 offset:0
    ds_read_b64_tr_b16 v[178:179], v208 offset:1024
    ds_read_b64_tr_b16 v[180:181], v209 offset:0
    ds_read_b64_tr_b16 v[182:183], v209 offset:1024
    v_mfma_f32_32x32x16_bf16 v[120:135], a[172:175], v[188:191], v[120:135]
    v_add_u32 v201, 0x8000, v201
    v_add_u32 v205, 0x8000, v205
    v_add_u32 v202, 0x8000, v202
    v_add_u32 v206, 0x8000, v206
    v_add_u32 v203, 0x8000, v203
    v_add_u32 v207, 0x8000, v207
    v_mfma_f32_32x32x16_bf16 v[152:167], v[172:175], v[188:191], v[152:167]
    s_cmp_lg_u32 s36, 0
    s_cbranch_scc1 L_f_q0N
    v_lshlrev_b32 v2, 2, v1
    v_mov_b32 v3, s67
    s_mov_b64 exec, 0xffffffff
    buffer_store_dword v3, v2, s[16:19], s33 offen sc1
    s_mov_b64 exec, -1
    s_branch L_f_q1N
L_f_q0N:
    buffer_load_dword v216, v14, s[4:7], 0 offen
L_f_q1N:
    s_waitcnt lgkmcnt(0)
    v_mfma_f32_32x32x16_bf16 v[104:119], a[176:179], v[176:179], v[104:119]
    ds_read_b128 a[180:183], v201
    ds_read_b128 v[172:175], v205
    ds_read_b64_tr_b16 v[184:185], v208 offset:4096
    v_mfma_f32_32x32x16_bf16 v[136:151], v[168:171], v[176:179], v[136:151]
    ds_read_b64_tr_b16 v[186:187], v208 offset:5120
    ds_read_b64_tr_b16 v[188:189], v209 offset:4096
    ds_read_b64_tr_b16 v[190:191], v209 offset:5120
    s_lshl_b32 s40, s44, 7
    s_add_u32 m0, s49, 131072
    s_add_u32 s40, s40, s45
    buffer_load_dwordx4 v218, s[4:7], s40 offen offset:0 lds
    v_mfma_f32_32x32x16_bf16 v[120:135], a[176:179], v[180:183], v[120:135]
    s_add_u32 s40, s40, 6144
    buffer_load_dwordx4 v218, s[4:7], s40 offen offset:1024 lds
    v_mfma_f32_32x32x16_bf16 v[152:167], v[168:171], v[180:183], v[152:167]
    s_add_u32 s40, s40, 6144
    buffer_load_dwordx4 v219, s[4:7], s40 offen offset:2048 lds
    s_waitcnt lgkmcnt(0)
    v_mfma_f32_32x32x16_bf16 v[104:119], a[180:183], v[184:187], v[104:119]
    ds_read_b128 a[184:187], v202
    ds_read_b128 v[168:171], v206
    ds_read_b64_tr_b16 v[176:177], v208 offset:8192
    v_mfma_f32_32x32x16_bf16 v[136:151], v[172:175], v[184:187], v[136:151]
    ds_read_b64_tr_b16 v[178:179], v208 offset:9216
    ds_read_b64_tr_b16 v[180:181], v209 offset:8192
    ds_read_b64_tr_b16 v[182:183], v209 offset:9216
    s_add_u32 s40, s40, 6144
    buffer_load_dwordx4 v219, s[4:7], s40 offen offset:3072 lds
    v_mfma_f32_32x32x16_bf16 v[120:135], a[180:183], v[188:191], v[120:135]
    s_mul_i32 s41, s44, 172032
    s_add_u32 m0, s50, 131072
    s_add_u32 s41, s41, s46
    buffer_load_dwordx4 v220, s[8:11], s41 offen offset:0 lds
    v_mfma_f32_32x32x16_bf16 v[152:167], v[172:175], v[188:191], v[152:167]
    s_add_u32 s41, s41, 9728
    buffer_load_dwordx4 v220, s[8:11], s41 offen offset:1024 lds
    s_waitcnt lgkmcnt(0)
    v_mfma_f32_32x32x16_bf16 v[104:119], a[184:187], v[176:179], v[104:119]
    ds_read_b128 a[188:191], v203
    ds_read_b128 v[172:175], v207
    ds_read_b64_tr_b16 v[184:185], v208 offset:12288
    v_mfma_f32_32x32x16_bf16 v[136:151], v[168:171], v[176:179], v[136:151]
    ds_read_b64_tr_b16 v[186:187], v208 offset:13312
    ds_read_b64_tr_b16 v[188:189], v209 offset:12288
    ds_read_b64_tr_b16 v[190:191], v209 offset:13312
    s_add_u32 s41, s41, 9728
    buffer_load_dwordx4 v220, s[8:11], s41 offen offset:2048 lds
    v_mfma_f32_32x32x16_bf16 v[120:135], a[184:187], v[180:183], v[120:135]
    s_add_u32 s41, s41, 9728
    buffer_load_dwordx4 v220, s[8:11], s41 offen offset:3072 lds
    s_add_u32 s44, s44, 1
    s_cmp_eq_u32 s44, 7
    s_cselect_b32 s44, 0, s44
    v_mfma_f32_32x32x16_bf16 v[152:167], v[168:171], v[180:183], v[152:167]
    s_waitcnt lgkmcnt(0)
    v_mfma_f32_32x32x16_bf16 v[104:119], a[188:191], v[184:187], v[104:119]
    s_waitcnt vmcnt(9)
    s_barrier
    v_add_u32 v200, 0x8000, v200
    v_add_u32 v204, 0x8000, v204
    v_add_u32 v208, 0x8000, v208
    v_add_u32 v209, 0x8000, v209
    v_mfma_f32_32x32x16_bf16 v[136:151], v[172:175], v[184:187], v[136:151]
    ds_read_b128 a[192:195], v200
    ds_read_b128 v[168:171], v204
    ds_read_b64_tr_b16 v[176:177], v208 offset:0
    ds_read_b64_tr_b16 v[178:179], v208 offset:1024
    ds_read_b64_tr_b16 v[180:181], v209 offset:0
    ds_read_b64_tr_b16 v[182:183], v209 offset:1024
    v_mfma_f32_32x32x16_bf16 v[120:135], a[188:191], v[188:191], v[120:135]
    v_add_u32 v201, 0x8000, v201
    v_add_u32 v205, 0x8000, v205
    v_add_u32 v202, 0x8000, v202
    v_add_u32 v206, 0x8000, v206
    v_add_u32 v203, 0x8000, v203
    v_add_u32 v207, 0x8000, v207
    v_mfma_f32_32x32x16_bf16 v[152:167], v[172:175], v[188:191], v[152:167]
    s_waitcnt lgkmcnt(0)
    v_mfma_f32_32x32x16_bf16 v[104:119], a[192:195], v[176:179], v[104:119]
    ds_read_b128 a[196:199], v201
    ds_read_b128 v[172:175], v205
    ds_read_b64_tr_b16 v[184:185], v208 offset:4096
    v_mfma_f32_32x32x16_bf16 v[136:151], v[168:171], v[176:179], v[136:151]
    ds_read_b64_tr_b16 v[186:187], v208 offset:5120
    ds_read_b64_tr_b16 v[188:189], v209 offset:4096
    ds_read_b64_tr_b16 v[190:191], v209 offset:5120
    s_lshl_b32 s40, s44, 7
    s_add_u32 m0, s49, 0
    s_add_u32 s40, s40, s45
    buffer_load_dwordx4 v218, s[4:7], s40 offen offset:0 lds
    v_mfma_f32_32x32x16_bf16 v[120:135], a[192:195], v[180:183], v[120:135]
    s_add_u32 s40, s40, 6144
    buffer_load_dwordx4 v218, s[4:7], s40 offen offset:1024 lds
    v_mfma_f32_32x32x16_bf16 v[152:167], v[168:171], v[180:183], v[152:167]
    s_add_u32 s40, s40, 6144
    buffer_load_dwordx4 v219, s[4:7], s40 offen offset:2048 lds
    s_waitcnt lgkmcnt(0)
    v_mfma_f32_32x32x16_bf16 v[104:119], a[196:199], v[184:187], v[104:119]
    ds_read_b128 a[200:203], v202
    ds_read_b128 v[168:171], v206
    ds_read_b64_tr_b16 v[176:177], v208 offset:8192
    v_mfma_f32_32x32x16_bf16 v[136:151], v[172:175], v[184:187], v[136:151]
    ds_read_b64_tr_b16 v[178:179], v208 offset:9216
    ds_read_b64_tr_b16 v[180:181], v209 offset:8192
    ds_read_b64_tr_b16 v[182:183], v209 offset:9216
    s_add_u32 s40, s40, 6144
    buffer_load_dwordx4 v219, s[4:7], s40 offen offset:3072 lds
    v_mfma_f32_32x32x16_bf16 v[120:135], a[196:199], v[188:191], v[120:135]
    s_mul_i32 s41, s44, 172032
    s_add_u32 m0, s50, 0
    s_add_u32 s41, s41, s46
    buffer_load_dwordx4 v220, s[8:11], s41 offen offset:0 lds
    v_mfma_f32_32x32x16_bf16 v[152:167], v[172:175], v[188:191], v[152:167]
    s_add_u32 s41, s41, 9728
    buffer_load_dwordx4 v220, s[8:11], s41 offen offset:1024 lds
    s_waitcnt lgkmcnt(0)
    v_mfma_f32_32x32x16_bf16 v[104:119], a[200:203], v[176:179], v[104:119]
    ds_read_b128 a[204:207], v203
    ds_read_b128 v[172:175], v207
    ds_read_b64_tr_b16 v[184:185], v208 offset:12288
    v_mfma_f32_32x32x16_bf16 v[136:151], v[168:171], v[176:179], v[136:151]
    ds_read_b64_tr_b16 v[186:187], v208 offset:13312
    ds_read_b64_tr_b16 v[188:189], v209 offset:12288
    ds_read_b64_tr_b16 v[190:191], v209 offset:13312
    s_add_u32 s41, s41, 9728
    buffer_load_dwordx4 v220, s[8:11], s41 offen offset:2048 lds
    v_mfma_f32_32x32x16_bf16 v[120:135], a[200:203], v[180:183], v[120:135]
    s_add_u32 s41, s41, 9728
    buffer_load_dwordx4 v220, s[8:11], s41 offen offset:3072 lds
    s_add_u32 s44, s44, 1
    s_cmp_eq_u32 s44, 7
    s_cselect_b32 s44, 0, s44
    v_mfma_f32_32x32x16_bf16 v[152:167], v[168:171], v[180:183], v[152:167]
    s_waitcnt lgkmcnt(0)
    v_mfma_f32_32x32x16_bf16 v[104:119], a[204:207], v[184:187], v[104:119]
    s_waitcnt vmcnt(8)
    s_barrier
    v_add_u32 v200, 0x8000, v200
    v_add_u32 v204, 0x8000, v204
    v_add_u32 v208, 0x8000, v208
    v_add_u32 v209, 0x8000, v209
    v_mfma_f32_32x32x16_bf16 v[136:151], v[172:175], v[184:187], v[136:151]
    ds_read_b128 a[208:211], v200
    ds_read_b128 v[168:171], v204
    ds_read_b64_tr_b16 v[176:177], v208 offset:0
    ds_read_b64_tr_b16 v[178:179], v208 offset:1024
    ds_read_b64_tr_b16 v[180:181], v209 offset:0
    ds_read_b64_tr_b16 v[182:183], v209 offset:1024
    v_mfma_f32_32x32x16_bf16 v[120:135], a[204:207], v[188:191], v[120:135]
    v_add_u32 v201, 0x8000, v201
    v_add_u32 v205, 0x8000, v205
    v_add_u32 v202, 0x8000, v202
    v_add_u32 v206, 0x8000, v206
    v_add_u32 v203, 0x8000, v203
    v_add_u32 v207, 0x8000, v207
    v_mfma_f32_32x32x16_bf16 v[152:167], v[172:175], v[188:191], v[152:167]
    s_waitcnt lgkmcnt(0)
    v_mfma_f32_32x32x16_bf16 v[104:119], a[208:211], v[176:179], v[104:119]
    ds_read_b128 a[212:215], v201
    ds_read_b128 v[172:175], v205
    ds_read_b64_tr_b16 v[184:185], v208 offset:4096
    v_mfma_f32_32x32x16_bf16 v[136:151], v[168:171], v[176:179], v[136:151]
    ds_read_b64_tr_b16 v[186:187], v208 offset:5120
    ds_read_b64_tr_b16 v[188:189], v209 offset:4096
    ds_read_b64_tr_b16 v[190:191], v209 offset:5120
    s_lshl_b32 s40, s44, 7
    s_add_u32 m0, s49, 32768
    s_add_u32 s40, s40, s45
    buffer_load_dwordx4 v218, s[4:7], s40 offen offset:0 lds
    v_mfma_f32_32x32x16_bf16 v[120:135], a[208:211], v[180:183], v[120:135]
    s_add_u32 s40, s40, 6144
    buffer_load_dwordx4 v218, s[4:7], s40 offen offset:1024 lds
    v_mfma_f32_32x32x16_bf16 v[152:167], v[168:171], v[180:183], v[152:167]
    s_add_u32 s40, s40, 6144
    buffer_load_dwordx4 v219, s[4:7], s40 offen offset:2048 lds
    s_waitcnt lgkmcnt(0)
    v_mfma_f32_32x32x16_bf16 v[104:119], a[212:215], v[184:187], v[104:119]
    ds_read_b128 a[216:219], v202
    ds_read_b128 v[168:171], v206
    ds_read_b64_tr_b16 v[176:177], v208 offset:8192
    v_mfma_f32_32x32x16_bf16 v[136:151], v[172:175], v[184:187], v[136:151]
    ds_read_b64_tr_b16 v[178:179], v208 offset:9216
    ds_read_b64_tr_b16 v[180:181], v209 offset:8192
    ds_read_b64_tr_b16 v[182:183], v209 offset:9216
    s_add_u32 s40, s40, 6144
    buffer_load_dwordx4 v219, s[4:7], s40 offen offset:3072 lds
    v_mfma_f32_32x32x16_bf16 v[120:135], a[212:215], v[188:191], v[120:135]
    s_mul_i32 s41, s44, 172032
    s_add_u32 m0, s50, 32768
    s_add_u32 s41, s41, s46
    buffer_load_dwordx4 v220, s[8:11], s41 offen offset:0 lds
    v_mfma_f32_32x32x16_bf16 v[152:167], v[172:175], v[188:191], v[152:167]
    s_add_u32 s41, s41, 9728
    buffer_load_dwordx4 v220, s[8:11], s41 offen offset:1024 lds
    s_waitcnt lgkmcnt(0)
    v_mfma_f32_32x32x16_bf16 v[104:119], a[216:219], v[176:179], v[104:119]
    ds_read_b128 a[220:223], v203
    ds_read_b128 v[172:175], v207
    ds_read_b64_tr_b16 v[184:185], v208 offset:12288
    v_mfma_f32_32x32x16_bf16 v[136:151], v[168:171], v[176:179], v[136:151]
    ds_read_b64_tr_b16 v[186:187], v208 offset:13312
    ds_read_b64_tr_b16 v[188:189], v209 offset:12288
    ds_read_b64_tr_b16 v[190:191], v209 offset:13312
    s_add_u32 s41, s41, 9728
    buffer_load_dwordx4 v220, s[8:11], s41 offen offset:2048 lds
    v_mfma_f32_32x32x16_bf16 v[120:135], a[216:219], v[180:183], v[120:135]
    s_add_u32 s41, s41, 9728
    buffer_load_dwordx4 v220, s[8:11], s41 offen offset:3072 lds
    s_add_u32 s44, s44, 1
    s_cmp_eq_u32 s44, 7
    s_cselect_b32 s44, 0, s44
    v_mfma_f32_32x32x16_bf16 v[152:167], v[168:171], v[180:183], v[152:167]
    s_waitcnt lgkmcnt(0)
    v_mfma_f32_32x32x16_bf16 v[104:119], a[220:223], v[184:187], v[104:119]
    s_waitcnt vmcnt(8)
    s_barrier
    v_add_u32 v200, 0xfffe0000, v200
    v_add_u32 v204, 0xfffe0000, v204
    v_add_u32 v208, 0xfffe0000, v208
    v_add_u32 v209, 0xfffe0000, v209
    v_mfma_f32_32x32x16_bf16 v[136:151], v[172:175], v[184:187], v[136:151]
    ds_read_b128 a[224:227], v200
    ds_read_b128 v[168:171], v204
    ds_read_b64_tr_b16 v[176:177], v208 offset:0
    ds_read_b64_tr_b16 v[178:179], v208 offset:1024
    ds_read_b64_tr_b16 v[180:181], v209 offset:0
    ds_read_b64_tr_b16 v[182:183], v209 offset:1024
    v_mfma_f32_32x32x16_bf16 v[120:135], a[220:223], v[188:191], v[120:135]
    v_add_u32 v201, 0xfffe0000, v201
    v_add_u32 v205, 0xfffe0000, v205
    v_add_u32 v202, 0xfffe0000, v202
    v_add_u32 v206, 0xfffe0000, v206
    v_add_u32 v203, 0xfffe0000, v203
    v_add_u32 v207, 0xfffe0000, v207
    v_mfma_f32_32x32x16_bf16 v[152:167], v[172:175], v[188:191], v[152:167]
    s_waitcnt lgkmcnt(0)
    v_mfma_f32_32x32x16_bf16 v[104:119], a[224:227], v[176:179], v[104:119]
    ds_read_b128 a[228:231], v201
    ds_read_b128 v[172:175], v205
    ds_read_b64_tr_b16 v[184:185], v208 offset:4096
    v_mfma_f32_32x32x16_bf16 v[136:151], v[168:171], v[176:179], v[136:151]
    ds_read_b64_tr_b16 v[186:187], v208 offset:5120
    ds_read_b64_tr_b16 v[188:189], v209 offset:4096
    ds_read_b64_tr_b16 v[190:191], v209 offset:5120
    v_mfma_f32_32x32x16_bf16 v[120:135], a[224:227], v[180:183], v[120:135]
    v_mfma_f32_32x32x16_bf16 v[152:167], v[168:171], v[180:183], v[152:167]
    s_waitcnt lgkmcnt(0)
    v_mfma_f32_32x32x16_bf16 v[104:119], a[228:231], v[184:187], v[104:119]
    ds_read_b128 a[232:235], v202
    ds_read_b128 v[168:171], v206
    ds_read_b64_tr_b16 v[176:177], v208 offset:8192
    v_mfma_f32_32x32x16_bf16 v[136:151], v[172:175], v[184:187], v[136:151]
    ds_read_b64_tr_b16 v[178:179], v208 offset:9216
    ds_read_b64_tr_b16 v[180:181], v209 offset:8192
    ds_read_b64_tr_b16 v[182:183], v209 offset:9216
    v_mfma_f32_32x32x16_bf16 v[120:135], a[228:231], v[188:191], v[120:135]
    v_mfma_f32_32x32x16_bf16 v[152:167], v[172:175], v[188:191], v[152:167]
    s_waitcnt lgkmcnt(0)
    v_mfma_f32_32x32x16_bf16 v[104:119], a[232:235], v[176:179], v[104:119]
    ds_read_b128 a[236:239], v203
    ds_read_b128 v[172:175], v207
    ds_read_b64_tr_b16 v[184:185], v208 offset:12288
    v_mfma_f32_32x32x16_bf16 v[136:151], v[168:171], v[176:179], v[136:151]
    ds_read_b64_tr_b16 v[186:187], v208 offset:13312
    ds_read_b64_tr_b16 v[188:189], v209 offset:12288
    ds_read_b64_tr_b16 v[190:191], v209 offset:13312
    v_mfma_f32_32x32x16_bf16 v[120:135], a[232:235], v[180:183], v[120:135]
    v_mfma_f32_32x32x16_bf16 v[152:167], v[168:171], v[180:183], v[152:167]
    buffer_load_dword v13, v217, s[16:19], 0 offen sc1
    s_waitcnt lgkmcnt(0)
    v_mfma_f32_32x32x16_bf16 v[104:119], a[236:239], v[184:187], v[104:119]
    s_waitcnt vmcnt(1)
    s_barrier
    v_add_u32 v200, 0x8000, v200
    v_add_u32 v204, 0x8000, v204
    v_add_u32 v208, 0x8000, v208
    v_add_u32 v209, 0x8000, v209
    v_mfma_f32_32x32x16_bf16 v[136:151], v[172:175], v[184:187], v[136:151]
    ds_read_b128 a[240:243], v200
    ds_read_b128 v[168:171], v204
    ds_read_b64_tr_b16 v[176:177], v208 offset:0
    ds_read_b64_tr_b16 v[178:179], v208 offset:1024
    ds_read_b64_tr_b16 v[180:181], v209 offset:0
    ds_read_b64_tr_b16 v[182:183], v209 offset:1024
    v_mfma_f32_32x32x16_bf16 v[120:135], a[236:239], v[188:191], v[120:135]
    v_add_u32 v201, 0x8000, v201
    v_add_u32 v205, 0x8000, v205
    v_add_u32 v202, 0x8000, v202
    v_add_u32 v206, 0x8000, v206
    v_add_u32 v203, 0x8000, v203
    v_add_u32 v207, 0x8000, v207
    v_mfma_f32_32x32x16_bf16 v[152:167], v[172:175], v[188:191], v[152:167]
    s_waitcnt lgkmcnt(0)
    v_mfma_f32_32x32x16_bf16 v[104:119], a[240:243], v[176:179], v[104:119]
    ds_read_b128 a[244:247], v201
    ds_read_b128 v[172:175], v205
    ds_read_b64_tr_b16 v[184:185], v208 offset:4096
    v_mfma_f32_32x32x16_bf16 v[136:151], v[168:171], v[176:179], v[136:151]
    ds_read_b64_tr_b16 v[186:187], v208 offset:5120
    ds_read_b64_tr_b16 v[188:189], v209 offset:4096
    ds_read_b64_tr_b16 v[190:191], v209 offset:5120
    v_mfma_f32_32x32x16_bf16 v[120:135], a[240:243], v[180:183], v[120:135]
    v_mfma_f32_32x32x16_bf16 v[152:167], v[168:171], v[180:183], v[152:167]
    s_waitcnt lgkmcnt(0)
    v_mfma_f32_32x32x16_bf16 v[104:119], a[244:247], v[184:187], v[104:119]
    ds_read_b128 a[248:251], v202
    ds_read_b128 v[168:171], v206
    ds_read_b64_tr_b16 v[176:177], v208 offset:8192
    v_mfma_f32_32x32x16_bf16 v[136:151], v[172:175], v[184:187], v[136:151]
    ds_read_b64_tr_b16 v[178:179], v208 offset:9216
    ds_read_b64_tr_b16 v[180:181], v209 offset:8192
    ds_read_b64_tr_b16 v[182:183], v209 offset:9216
    v_mfma_f32_32x32x16_bf16 v[120:135], a[244:247], v[188:191], v[120:135]
    v_mfma_f32_32x32x16_bf16 v[152:167], v[172:175], v[188:191], v[152:167]
    s_waitcnt lgkmcnt(0)
    v_mfma_f32_32x32x16_bf16 v[104:119], a[248:251], v[176:179], v[104:119]
    ds_read_b128 a[252:255], v203
    ds_read_b128 v[172:175], v207
    ds_read_b64_tr_b16 v[184:185], v208 offset:12288
    v_mfma_f32_32x32x16_bf16 v[136:151], v[168:171], v[176:179], v[136:151]
    ds_read_b64_tr_b16 v[186:187], v208 offset:13312
    ds_read_b64_tr_b16 v[188:189], v209 offset:12288
    ds_read_b64_tr_b16 v[190:191], v209 offset:13312
    v_mfma_f32_32x32x16_bf16 v[120:135], a[248:251], v[180:183], v[120:135]
    v_mfma_f32_32x32x16_bf16 v[152:167], v[168:171], v[180:183], v[152:167]
    s_waitcnt lgkmcnt(0)
    v_mfma_f32_32x32x16_bf16 v[104:119], a[252:255], v[184:187], v[104:119]
    v_mfma_f32_32x32x16_bf16 v[136:151], v[172:175], v[184:187], v[136:151]
    v_mfma_f32_32x32x16_bf16 v[120:135], a[252:255], v[188:191], v[120:135]
    v_mfma_f32_32x32x16_bf16 v[152:167], v[172:175], v[188:191], v[152:167]
    s_cmp_lg_u32 s39, 1
    s_cbranch_scc1 L_f_B
    s_mov_b32 exec_lo, 0xefffffff
    s_mov_b32 exec_hi, 0xefffffff
    s_nop 5
    v_cvt_pk_bf16_f32 v32, v104, v105
    v_cvt_pk_bf16_f32 v33, v106, v107
    v_cvt_pk_bf16_f32 v34, v108, v109
    v_cvt_pk_bf16_f32 v35, v110, v111
    v_cvt_pk_bf16_f32 v36, v112, v113
    v_cvt_pk_bf16_f32 v37, v114, v115
    v_cvt_pk_bf16_f32 v38, v116, v117
    v_cvt_pk_bf16_f32 v39, v118, v119
    s_mov_b64 exec, -1
    buffer_store_dwordx4 v[32:35], v6, s[16:19], s56 offen offset:2048 sc1
L_f_pad3:
    s_cbranch_execz L_f_pad7
    buffer_store_dwordx4 v[36:39], v6, s[16:19], s56 offen offset:3072 sc1
    s_add_u32 s56, s56, 262144
    s_mov_b32 exec_lo, 0xefffffff
    s_mov_b32 exec_hi, 0xefffffff
    v_cvt_pk_bf16_f32 v48, v136, v137
    v_cvt_pk_bf16_f32 v49, v138, v139
    v_cvt_pk_bf16_f32 v50, v140, v141
    v_cvt_pk_bf16_f32 v51, v142, v143
    v_cvt_pk_bf16_f32 v52, v144, v145
    v_cvt_pk_bf16_f32 v53, v146, v147
    v_cvt_pk_bf16_f32 v54, v148, v149
    v_cvt_pk_bf16_f32 v55, v150, v151
    s_mov_b64 exec, -1
    buffer_store_dwordx4 v[48:51], v6, s[16:19], s57 offen offset:2048 sc1
    buffer_store_dwordx4 v[52:55], v6, s[16:19], s57 offen offset:3072 sc1
    s_add_u32 s57, s57, 262144
    s_mov_b32 exec_lo, 0xefffffff
    s_mov_b32 exec_hi, 0xefffffff
    v_cvt_pk_bf16_f32 v40, v120, v121
    v_cvt_pk_bf16_f32 v41, v122, v123
    v_cvt_pk_bf16_f32 v42, v124, v125
    v_cvt_pk_bf16_f32 v43, v126, v127
    v_cvt_pk_bf16_f32 v44, v128, v129
    v_cvt_pk_bf16_f32 v45, v130, v131
    v_cvt_pk_bf16_f32 v46, v132, v133
    v_cvt_pk_bf16_f32 v47, v134, v135
    s_mov_b64 exec, -1
    buffer_store_dwordx4 v[40:43], v6, s[16:19], s56 offen offset:2048 sc1
    buffer_store_dwordx4 v[44:47], v6, s[16:19], s56 offen offset:3072 sc1
    s_mov_b32 exec_lo, 0xefffffff
    s_mov_b32 exec_hi, 0xefffffff
    v_cvt_pk_bf16_f32 v96, v152, v153
    v_cvt_pk_bf16_f32 v97, v154, v155
    v_cvt_pk_bf16_f32 v98, v156, v157
    v_cvt_pk_bf16_f32 v99, v158, v159
    v_cvt_pk_bf16_f32 v100, v160, v161
    v_cvt_pk_bf16_f32 v101, v162, v163
    v_cvt_pk_bf16_f32 v102, v164, v165
    v_cvt_pk_bf16_f32 v103, v166, v167
    s_mov_b64 exec, -1
    buffer_store_dwordx4 v[96:99], v6, s[16:19], s57 offen offset:2048 sc1
    buffer_store_dwordx4 v[100:103], v6, s[16:19], s57 offen offset:3072 sc1
L_f_kvpub:
L_f_pad4:
    s_cbranch_execz L_f_pad8
    s_waitcnt vmcnt(8)
    s_mov_b32 s35, 0
L_f_pollQa:
    v_cmp_ne_u32 vcc, s67, v13
    s_cbranch_vccz L_f_pollQa_done
    buffer_load_dword v13, v217, s[16:19], 0 offen sc1
    s_add_u32 s35, s35, 1
    s_cmp_lt_u32 s35, 262144
    s_waitcnt vmcnt(0)
    s_cbranch_scc1 L_f_pollQa
L_f_pollQa_done:
    s_lshl_b32 s41, s44, 13
    s_lshr_b32 s40, s49, 1
    s_add_u32 m0, s40, 65536
    s_add_u32 s41, s41, s32
    buffer_load_dwordx4 v6, s[16:19], s41 offen sc1 lds
    s_add_u32 s44, s44, 1
    buffer_load_dwordx4 v6, s[16:19], s41 offen offset:1024 sc1 lds
    s_cmp_eq_u32 s44, 7
    s_cselect_b32 s44, 0, s44
    s_lshl_b32 s41, s44, 13
    s_lshr_b32 s40, s49, 1
    s_add_u32 m0, s40, 73728
    s_add_u32 s41, s41, s32
    buffer_load_dwordx4 v6, s[16:19], s41 offen sc1 lds
    s_add_u32 s44, s44, 1
    buffer_load_dwordx4 v6, s[16:19], s41 offen offset:1024 sc1 lds
    s_cmp_eq_u32 s44, 7
    s_cselect_b32 s44, 0, s44
    s_lshl_b32 s41, s44, 13
    s_lshr_b32 s40, s49, 1
    s_add_u32 m0, s40, 81920
    s_add_u32 s41, s41, s32
    buffer_load_dwordx4 v6, s[16:19], s41 offen sc1 lds
    s_add_u32 s44, s44, 1
    buffer_load_dwordx4 v6, s[16:19], s41 offen offset:1024 sc1 lds
    s_cmp_eq_u32 s44, 7
    s_cselect_b32 s44, 0, s44
    s_lshl_b32 s41, s44, 13
    s_lshr_b32 s40, s49, 1
    s_add_u32 m0, s40, 90112
    s_add_u32 s41, s41, s32
    buffer_load_dwordx4 v6, s[16:19], s41 offen sc1 lds
    s_add_u32 s44, s44, 1
    buffer_load_dwordx4 v6, s[16:19], s41 offen offset:1024 sc1 lds
    s_cmp_eq_u32 s44, 7
    s_cselect_b32 s44, 0, s44
    s_waitcnt vmcnt(8)
    s_barrier
    s_cmp_lg_u32 s36, 0
    s_cbranch_scc1 L_f_kv0
    v_lshlrev_b32 v2, 2, v1
    v_mov_b32 v3, s67
    s_mov_b64 exec, 0xffffffff
    buffer_store_dword v3, v2, s[16:19], s55 offen sc1
    s_mov_b64 exec, -1
    s_branch L_f_kv1
L_f_kv0:
    buffer_load_dword v216, v14, s[4:7], 0 offen
L_f_kv1:
    s_lshl_b32 s41, s44, 13
    s_lshr_b32 s40, s49, 1
    s_add_u32 m0, s40, 98304
    s_add_u32 s41, s41, s32
    buffer_load_dwordx4 v6, s[16:19], s41 offen sc1 lds
    s_add_u32 s44, s44, 1
    buffer_load_dwordx4 v6, s[16:19], s41 offen offset:1024 sc1 lds
    s_cmp_eq_u32 s44, 7
    s_cselect_b32 s44, 0, s44
    s_lshl_b32 s41, s44, 13
    s_lshr_b32 s40, s49, 1
    s_add_u32 m0, s40, 106496
    s_add_u32 s41, s41, s32
    buffer_load_dwordx4 v6, s[16:19], s41 offen sc1 lds
    s_add_u32 s44, s44, 1
    buffer_load_dwordx4 v6, s[16:19], s41 offen offset:1024 sc1 lds
    s_cmp_eq_u32 s44, 7
    s_cselect_b32 s44, 0, s44
    s_lshl_b32 s41, s44, 13
    s_lshr_b32 s40, s49, 1
    s_add_u32 m0, s40, 114688
    s_add_u32 s41, s41, s32
    buffer_load_dwordx4 v6, s[16:19], s41 offen sc1 lds
    s_add_u32 s44, s44, 1
    buffer_load_dwordx4 v6, s[16:19], s41 offen offset:1024 sc1 lds
    s_cmp_eq_u32 s44, 7
    s_cselect_b32 s44, 0, s44
    s_waitcnt vmcnt(7)
    s_barrier
    s_branch L_f_pass2
L_f_B:
L_f_pad5:
    s_cbranch_execz L_f_pad9
    s_mov_b32 s42, 0x3fb8aa3b
    s_mov_b32 s54, 0x358637bd
    s_waitcnt vmcnt(0)
    s_mov_b32 s35, 0
L_f_pollQb:
    v_cmp_ne_u32 vcc, s67, v13
    s_cbranch_vccz L_f_pollQb_done
    buffer_load_dword v13, v217, s[16:19], 0 offen sc1
    s_add_u32 s35, s35, 1
    s_cmp_lt_u32 s35, 262144
    s_waitcnt vmcnt(0)
    s_cbranch_scc1 L_f_pollQb
L_f_pollQb_done:
    s_lshl_b32 s41, s44, 13
    s_lshr_b32 s40, s49, 1
    s_add_u32 m0, s40, 65536
    s_add_u32 s41, s41, s32
    buffer_load_dwordx4 v6, s[16:19], s41 offen sc1 lds
    s_add_u32 s44, s44, 1
    buffer_load_dwordx4 v6, s[16:19], s41 offen offset:1024 sc1 lds
    s_cmp_eq_u32 s44, 7
    s_cselect_b32 s44, 0, s44
    s_lshl_b32 s41, s44, 13
    s_lshr_b32 s40, s49, 1
    s_add_u32 m0, s40, 73728
    s_add_u32 s41, s41, s32
    buffer_load_dwordx4 v6, s[16:19], s41 offen sc1 lds
    s_add_u32 s44, s44, 1
    buffer_load_dwordx4 v6, s[16:19], s41 offen offset:1024 sc1 lds
    s_cmp_eq_u32 s44, 7
    s_cselect_b32 s44, 0, s44
    v_mul_f32 v192, s42, v104
    v_mul_f32 v193, s42, v105
    v_mul_f32 v194, s42, v106
    v_mul_f32 v195, s42, v107
    v_mul_f32 v196, s42, v108
    v_mul_f32 v197, s42, v109
    v_mul_f32 v198, s42, v110
    v_mul_f32 v199, s42, v111
    v_exp_f32_e64 v192, v192 clamp
    v_exp_f32_e64 v193, v193 clamp
    v_exp_f32_e64 v194, v194 clamp
    v_exp_f32_e64 v195, v195 clamp
    v_exp_f32_e64 v196, v196 clamp
    v_exp_f32_e64 v197, v197 clamp
    v_exp_f32_e64 v198, v198 clamp
    v_exp_f32_e64 v199, v199 clamp
    s_lshl_b32 s41, s44, 13
    s_lshr_b32 s40, s49, 1
    s_add_u32 m0, s40, 81920
    s_add_u32 s41, s41, s32
    buffer_load_dwordx4 v6, s[16:19], s41 offen sc1 lds
    v_max_f32 v104, s54, v104
    v_max_f32 v105, s54, v105
    v_max_f32 v106, s54, v106
    v_max_f32 v107, s54, v107
    v_max_f32 v108, s54, v108
    v_max_f32 v109, s54, v109
    v_max_f32 v110, s54, v110
    v_max_f32 v111, s54, v111
    v_add_f32 v104, v104, v192
    v_add_f32 v105, v105, v193
    v_add_f32 v106, v106, v194
    v_add_f32 v107, v107, v195
    v_add_f32 v108, v108, v196
    v_add_f32 v109, v109, v197
    v_add_f32 v110, v110, v198
    v_add_f32 v111, v111, v199
    s_add_u32 s44, s44, 1
    buffer_load_dwordx4 v6, s[16:19], s41 offen offset:1024 sc1 lds
    s_cmp_eq_u32 s44, 7
    s_cselect_b32 s44, 0, s44
    s_lshl_b32 s41, s44, 13
    s_lshr_b32 s40, s49, 1
    s_add_u32 m0, s40, 90112
    s_add_u32 s41, s41, s32
    buffer_load_dwordx4 v6, s[16:19], s41 offen sc1 lds
    v_mul_f32 v192, s42, v112
    v_mul_f32 v193, s42, v113
    v_mul_f32 v194, s42, v114
    v_mul_f32 v195, s42, v115
    v_mul_f32 v196, s42, v116
    v_mul_f32 v197, s42, v117
    v_mul_f32 v198, s42, v118
    v_mul_f32 v199, s42, v119
    v_exp_f32_e64 v192, v192 clamp
    v_exp_f32_e64 v193, v193 clamp
    v_exp_f32_e64 v194, v194 clamp
    v_exp_f32_e64 v195, v195 clamp
    v_exp_f32_e64 v196, v196 clamp
    v_exp_f32_e64 v197, v197 clamp
    v_exp_f32_e64 v198, v198 clamp
    v_exp_f32_e64 v199, v199 clamp
    s_add_u32 s44, s44, 1
    buffer_load_dwordx4 v6, s[16:19], s41 offen offset:1024 sc1 lds
    s_cmp_eq_u32 s44, 7
    s_cselect_b32 s44, 0, s44
    v_max_f32 v112, s54, v112
    v_max_f32 v113, s54, v113
    v_max_f32 v114, s54, v114
    v_max_f32 v115, s54, v115
    v_max_f32 v116, s54, v116
    v_max_f32 v117, s54, v117
    v_max_f32 v118, s54, v118
    v_max_f32 v119, s54, v119
    v_add_f32 v112, v112, v192
    v_add_f32 v113, v113, v193
    v_add_f32 v114, v114, v194
    v_add_f32 v115, v115, v195
    v_add_f32 v116, v116, v196
    v_add_f32 v117, v117, v197
    v_add_f32 v118, v118, v198
    v_add_f32 v119, v119, v199
    s_mov_b32 exec_lo, 0xefffffff
    s_mov_b32 exec_hi, 0xefffffff
    v_cvt_pk_bf16_f32 v40, v120, v121
    v_cvt_pk_bf16_f32 v41, v122, v123
    v_cvt_pk_bf16_f32 v42, v124, v125
    v_cvt_pk_bf16_f32 v43, v126, v127
    v_cvt_pk_bf16_f32 v44, v128, v129
    v_cvt_pk_bf16_f32 v45, v130, v131
    v_cvt_pk_bf16_f32 v46, v132, v133
    v_cvt_pk_bf16_f32 v47, v134, v135
    s_mov_b32 exec_lo, 0x0fffffff
    s_mov_b32 exec_hi, 0x0fffffff
    v_cvt_pk_bf16_f32 v32, v104, v105
    v_cvt_pk_bf16_f32 v33, v106, v107
    v_cvt_pk_bf16_f32 v34, v108, v109
    v_cvt_pk_bf16_f32 v35, v110, v111
    v_cvt_pk_bf16_f32 v36, v112, v113
    v_cvt_pk_bf16_f32 v37, v114, v115
    v_cvt_pk_bf16_f32 v38, v116, v117
    v_cvt_pk_bf16_f32 v39, v118, v119
    s_mov_b64 exec, -1
    s_nop 0
    v_mfma_f32_32x32x16_bf16 v[64:79], v[32:35], v[40:43], 0
    v_mfma_f32_32x32x16_bf16 v[64:79], v[36:39], v[44:47], v[64:79]
    s_lshl_b32 s41, s44, 13
    s_lshr_b32 s40, s49, 1
    s_add_u32 m0, s40, 98304
    s_add_u32 s41, s41, s32
    buffer_load_dwordx4 v6, s[16:19], s41 offen sc1 lds
    s_add_u32 s44, s44, 1
    buffer_load_dwordx4 v6, s[16:19], s41 offen offset:1024 sc1 lds
    s_cmp_eq_u32 s44, 7
    s_cselect_b32 s44, 0, s44
    v_mul_f32 v192, s42, v136
    v_mul_f32 v193, s42, v137
    v_mul_f32 v194, s42, v138
    v_mul_f32 v195, s42, v139
    v_mul_f32 v196, s42, v140
    v_mul_f32 v197, s42, v141
    v_mul_f32 v198, s42, v142
    v_mul_f32 v199, s42, v143
    v_exp_f32_e64 v192, v192 clamp
    v_exp_f32_e64 v193, v193 clamp
    v_exp_f32_e64 v194, v194 clamp
    v_exp_f32_e64 v195, v195 clamp
    v_exp_f32_e64 v196, v196 clamp
    v_exp_f32_e64 v197, v197 clamp
    v_exp_f32_e64 v198, v198 clamp
    v_exp_f32_e64 v199, v199 clamp
    s_lshl_b32 s41, s44, 13
    s_lshr_b32 s40, s49, 1
    s_add_u32 m0, s40, 106496
    s_add_u32 s41, s41, s32
    buffer_load_dwordx4 v6, s[16:19], s41 offen sc1 lds
    v_max_f32 v136, s54, v136
    v_max_f32 v137, s54, v137
    v_max_f32 v138, s54, v138
    v_max_f32 v139, s54, v139
    v_max_f32 v140, s54, v140
    v_max_f32 v141, s54, v141
    v_max_f32 v142, s54, v142
    v_max_f32 v143, s54, v143
    v_add_f32 v136, v136, v192
    v_add_f32 v137, v137, v193
    v_add_f32 v138, v138, v194
    v_add_f32 v139, v139, v195
    v_add_f32 v140, v140, v196
    v_add_f32 v141, v141, v197
    v_add_f32 v142, v142, v198
    v_add_f32 v143, v143, v199
    s_add_u32 s44, s44, 1
    buffer_load_dwordx4 v6, s[16:19], s41 offen offset:1024 sc1 lds
    s_cmp_eq_u32 s44, 7
    s_cselect_b32 s44, 0, s44
    s_lshl_b32 s41, s44, 13
    s_lshr_b32 s40, s49, 1
    s_add_u32 m0, s40, 114688
    s_add_u32 s41, s41, s32
    buffer_load_dwordx4 v6, s[16:19], s41 offen sc1 lds
    v_mul_f32 v192, s42, v144
    v_mul_f32 v193, s42, v145
    v_mul_f32 v194, s42, v146
    v_mul_f32 v195, s42, v147
    v_mul_f32 v196, s42, v148
    v_mul_f32 v197, s42, v149
    v_mul_f32 v198, s42, v150
    v_mul_f32 v199, s42, v151
    v_exp_f32_e64 v192, v192 clamp
    v_exp_f32_e64 v193, v193 clamp
    v_exp_f32_e64 v194, v194 clamp
    v_exp_f32_e64 v195, v195 clamp
    v_exp_f32_e64 v196, v196 clamp
    v_exp_f32_e64 v197, v197 clamp
    v_exp_f32_e64 v198, v198 clamp
    v_exp_f32_e64 v199, v199 clamp
    s_add_u32 s44, s44, 1
    buffer_load_dwordx4 v6, s[16:19], s41 offen offset:1024 sc1 lds
    s_cmp_eq_u32 s44, 7
    s_cselect_b32 s44, 0, s44
    v_max_f32 v144, s54, v144
    v_max_f32 v145, s54, v145
    v_max_f32 v146, s54, v146
    v_max_f32 v147, s54, v147
    v_max_f32 v148, s54, v148
    v_max_f32 v149, s54, v149
    v_max_f32 v150, s54, v150
    v_max_f32 v151, s54, v151
    v_add_f32 v144, v144, v192
    v_add_f32 v145, v145, v193
    v_add_f32 v146, v146, v194
    v_add_f32 v147, v147, v195
    v_add_f32 v148, v148, v196
    v_add_f32 v149, v149, v197
    v_add_f32 v150, v150, v198
    v_add_f32 v151, v151, v199
    s_mov_b32 exec_lo, 0xefffffff
    s_mov_b32 exec_hi, 0xefffffff
    v_cvt_pk_bf16_f32 v96, v152, v153
    v_cvt_pk_bf16_f32 v97, v154, v155
    v_cvt_pk_bf16_f32 v98, v156, v157
    v_cvt_pk_bf16_f32 v99, v158, v159
    v_cvt_pk_bf16_f32 v100, v160, v161
    v_cvt_pk_bf16_f32 v101, v162, v163
    v_cvt_pk_bf16_f32 v102, v164, v165
    v_cvt_pk_bf16_f32 v103, v166, v167
    s_mov_b32 exec_lo, 0x0fffffff
    s_mov_b32 exec_hi, 0x0fffffff
    v_cvt_pk_bf16_f32 v48, v136, v137
    v_cvt_pk_bf16_f32 v49, v138, v139
    v_cvt_pk_bf16_f32 v50, v140, v141
    v_cvt_pk_bf16_f32 v51, v142, v143
    v_cvt_pk_bf16_f32 v52, v144, v145
    v_cvt_pk_bf16_f32 v53, v146, v147
    v_cvt_pk_bf16_f32 v54, v148, v149
    v_cvt_pk_bf16_f32 v55, v150, v151
    s_mov_b64 exec, -1
    s_nop 0
    v_mfma_f32_32x32x16_bf16 v[64:79], v[48:51], v[96:99], v[64:79]
    v_mfma_f32_32x32x16_bf16 v[64:79], v[52:55], v[100:103], v[64:79]
    s_waitcnt vmcnt(6)
    s_nop 5
    s_cmp_eq_u32 s48, 1
    s_nop 3
    s_cbranch_scc1 L_f_b1
    ds_write_b128 v222, v[72:75]
    ds_write_b128 v222, v[76:79] offset:1024
    s_waitcnt lgkmcnt(0)
    s_barrier
    ds_read_b128 v[192:195], v223
    ds_read_b128 v[196:199], v223 offset:1024
    s_waitcnt lgkmcnt(0)
    v_add_f32 v240, v64, v192
    v_add_f32 v241, v65, v193
    v_add_f32 v242, v66, v194
    v_add_f32 v243, v67, v195
    v_add_f32 v244, v68, v196
    v_add_f32 v245, v69, v197
    v_add_f32 v246, v70, v198
    v_add_f32 v247, v71, v199
    s_branch L_f_b2
L_f_b1:
    ds_write_b128 v222, v[64:67]
    ds_write_b128 v222, v[68:71] offset:1024
    s_waitcnt lgkmcnt(0)
    s_barrier
    ds_read_b128 v[192:195], v223
    ds_read_b128 v[196:199], v223 offset:1024
    s_waitcnt lgkmcnt(0)
    v_add_f32 v240, v72, v192
    v_add_f32 v241, v73, v193
    v_add_f32 v242, v74, v194
    v_add_f32 v243, v75, v195
    v_add_f32 v244, v76, v196
    v_add_f32 v245, v77, v197
    v_add_f32 v246, v78, v198
    v_add_f32 v247, v79, v199
L_f_b2:
    buffer_store_dwordx4 v[240:243], v6, s[16:19], s56 offen sc1
    buffer_store_dwordx4 v[244:247], v6, s[16:19], s57 offen sc1
L_f_pass2:
L_f_pad6:
    s_cbranch_execz L_f_pad10
    ds_read_b64_tr_b16 v[176:177], v210 offset:0
    ds_read_b64_tr_b16 v[178:179], v210 offset:512
    ds_read_b64_tr_b16 v[180:181], v227 offset:0
    ds_read_b64_tr_b16 v[182:183], v227 offset:512
    ds_read_b64_tr_b16 v[184:185], v210 offset:2048
    ds_read_b64_tr_b16 v[186:187], v210 offset:2560
    ds_read_b64_tr_b16 v[188:189], v227 offset:2048
    ds_read_b64_tr_b16 v[190:191], v227 offset:2560
    s_waitcnt lgkmcnt(4)
    v_mfma_f32_32x32x16_bf16 v[64:79], v[176:179], a[144:147], 0
    ds_read_b64_tr_b16 v[192:193], v210 offset:4096
    ds_read_b64_tr_b16 v[194:195], v210 offset:4608
    v_mfma_f32_32x32x16_bf16 v[80:95], v[180:183], a[144:147], 0
    ds_read_b64_tr_b16 v[196:197], v227 offset:4096
    ds_read_b64_tr_b16 v[198:199], v227 offset:4608
    s_waitcnt lgkmcnt(4)
    v_mfma_f32_32x32x16_bf16 v[64:79], v[184:187], a[148:151], v[64:79]
    ds_read_b64_tr_b16 v[176:177], v210 offset:6144
    ds_read_b64_tr_b16 v[178:179], v210 offset:6656
    v_mfma_f32_32x32x16_bf16 v[80:95], v[188:191], a[148:151], v[80:95]
    ds_read_b64_tr_b16 v[180:181], v227 offset:6144
    ds_read_b64_tr_b16 v[182:183], v227 offset:6656
    s_waitcnt lgkmcnt(4)
    v_mfma_f32_32x32x16_bf16 v[64:79], v[192:195], a[152:155], v[64:79]
    ds_read_b64_tr_b16 v[184:185], v210 offset:8192
    ds_read_b64_tr_b16 v[186:187], v210 offset:8704
    v_mfma_f32_32x32x16_bf16 v[80:95], v[196:199], a[152:155], v[80:95]
    ds_read_b64_tr_b16 v[188:189], v227 offset:8192
    ds_read_b64_tr_b16 v[190:191], v227 offset:8704
    s_waitcnt lgkmcnt(4)
    v_mfma_f32_32x32x16_bf16 v[64:79], v[176:179], a[156:159], v[64:79]
    ds_read_b64_tr_b16 v[192:193], v210 offset:10240
    ds_read_b64_tr_b16 v[194:195], v210 offset:10752
    v_mfma_f32_32x32x16_bf16 v[80:95], v[180:183], a[156:159], v[80:95]
    ds_read_b64_tr_b16 v[196:197], v227 offset:10240
    ds_read_b64_tr_b16 v[198:199], v227 offset:10752
    s_waitcnt lgkmcnt(4)
    v_mfma_f32_32x32x16_bf16 v[64:79], v[184:187], a[160:163], v[64:79]
    ds_read_b64_tr_b16 v[176:177], v210 offset:12288
    ds_read_b64_tr_b16 v[178:179], v210 offset:12800
    v_mfma_f32_32x32x16_bf16 v[80:95], v[188:191], a[160:163], v[80:95]
    ds_read_b64_tr_b16 v[180:181], v227 offset:12288
    ds_read_b64_tr_b16 v[182:183], v227 offset:12800
    s_waitcnt lgkmcnt(4)
    v_mfma_f32_32x32x16_bf16 v[64:79], v[192:195], a[164:167], v[64:79]
    ds_read_b64_tr_b16 v[184:185], v210 offset:14336
    ds_read_b64_tr_b16 v[186:187], v210 offset:14848
    v_mfma_f32_32x32x16_bf16 v[80:95], v[196:199], a[164:167], v[80:95]
    ds_read_b64_tr_b16 v[188:189], v227 offset:14336
    ds_read_b64_tr_b16 v[190:191], v227 offset:14848
    s_waitcnt lgkmcnt(4)
    v_mfma_f32_32x32x16_bf16 v[64:79], v[176:179], a[168:171], v[64:79]
    ds_read_b64_tr_b16 v[192:193], v210 offset:16384
    ds_read_b64_tr_b16 v[194:195], v210 offset:16896
    v_mfma_f32_32x32x16_bf16 v[80:95], v[180:183], a[168:171], v[80:95]
    buffer_load_dword v13, v14, s[16:19], 0 offen sc1
    ds_read_b64_tr_b16 v[196:197], v227 offset:16384
    ds_read_b64_tr_b16 v[198:199], v227 offset:16896
    s_waitcnt lgkmcnt(4)
    v_mfma_f32_32x32x16_bf16 v[64:79], v[184:187], a[172:175], v[64:79]
    ds_read_b64_tr_b16 v[176:177], v210 offset:18432
    ds_read_b64_tr_b16 v[178:179], v210 offset:18944
    v_mfma_f32_32x32x16_bf16 v[80:95], v[188:191], a[172:175], v[80:95]
    ds_read_b64_tr_b16 v[180:181], v227 offset:18432
    ds_read_b64_tr_b16 v[182:183], v227 offset:18944
    s_waitcnt lgkmcnt(4)
    v_mfma_f32_32x32x16_bf16 v[64:79], v[192:195], a[176:179], v[64:79]
    ds_read_b64_tr_b16 v[184:185], v210 offset:20480
    ds_read_b64_tr_b16 v[186:187], v210 offset:20992
    v_mfma_f32_32x32x16_bf16 v[80:95], v[196:199], a[176:179], v[80:95]
    ds_read_b64_tr_b16 v[188:189], v227 offset:20480
    ds_read_b64_tr_b16 v[190:191], v227 offset:20992
    s_waitcnt lgkmcnt(4)
    v_mfma_f32_32x32x16_bf16 v[64:79], v[176:179], a[180:183], v[64:79]
    ds_read_b64_tr_b16 v[192:193], v210 offset:22528
    ds_read_b64_tr_b16 v[194:195], v210 offset:23040
    v_mfma_f32_32x32x16_bf16 v[80:95], v[180:183], a[180:183], v[80:95]
    ds_read_b64_tr_b16 v[196:197], v227 offset:22528
    ds_read_b64_tr_b16 v[198:199], v227 offset:23040
    s_waitcnt lgkmcnt(4)
    v_mfma_f32_32x32x16_bf16 v[64:79], v[184:187], a[184:187], v[64:79]
    ds_read_b64_tr_b16 v[176:177], v210 offset:24576
    ds_read_b64_tr_b16 v[178:179], v210 offset:25088
    v_mfma_f32_32x32x16_bf16 v[80:95], v[188:191], a[184:187], v[80:95]
    ds_read_b64_tr_b16 v[180:181], v227 offset:24576
    ds_read_b64_tr_b16 v[182:183], v227 offset:25088
    s_waitcnt lgkmcnt(4)
    v_mfma_f32_32x32x16_bf16 v[64:79], v[192:195], a[188:191], v[64:79]
    ds_read_b64_tr_b16 v[184:185], v210 offset:26624
    ds_read_b64_tr_b16 v[186:187], v210 offset:27136
    v_mfma_f32_32x32x16_bf16 v[80:95], v[196:199], a[188:191], v[80:95]
    ds_read_b64_tr_b16 v[188:189], v227 offset:26624
    ds_read_b64_tr_b16 v[190:191], v227 offset:27136
    s_waitcnt lgkmcnt(4)
    v_mfma_f32_32x32x16_bf16 v[64:79], v[176:179], a[192:195], v[64:79]
    ds_read_b64_tr_b16 v[192:193], v210 offset:28672
    ds_read_b64_tr_b16 v[194:195], v210 offset:29184
    v_mfma_f32_32x32x16_bf16 v[80:95], v[180:183], a[192:195], v[80:95]
    ds_read_b64_tr_b16 v[196:197], v227 offset:28672
    ds_read_b64_tr_b16 v[198:199], v227 offset:29184
    s_waitcnt lgkmcnt(4)
    v_mfma_f32_32x32x16_bf16 v[64:79], v[184:187], a[196:199], v[64:79]
    ds_read_b64_tr_b16 v[176:177], v210 offset:30720
    ds_read_b64_tr_b16 v[178:179], v210 offset:31232
    v_mfma_f32_32x32x16_bf16 v[80:95], v[188:191], a[196:199], v[80:95]
    ds_read_b64_tr_b16 v[180:181], v227 offset:30720
    ds_read_b64_tr_b16 v[182:183], v227 offset:31232
    s_waitcnt vmcnt(0)
    v_cmp_ne_u32 vcc, s67, v13
    s_barrier
    s_cmp_eq_u32 s51, 0
    s_cbranch_scc1 L_f_nofb
    s_cmp_lg_u32 s36, 0
    s_cbranch_scc1 L_f_nofb
    v_lshlrev_b32 v2, 2, v1
    v_mov_b32 v3, s67
    s_mov_b64 exec, 0xffffffff
    buffer_store_dword v3, v2, s[16:19], s55 offen sc1
    s_mov_b64 exec, -1
L_f_nofb:
    s_cbranch_vccnz L_f_late
    s_mov_b32 s44, 1
    s_waitcnt lgkmcnt(4)
    v_mfma_f32_32x32x16_bf16 v[64:79], v[192:195], a[200:203], v[64:79]
    ds_read_b64_tr_b16 v[184:185], v210 offset:32768
    ds_read_b64_tr_b16 v[186:187], v210 offset:33280
    v_mfma_f32_32x32x16_bf16 v[80:95], v[196:199], a[200:203], v[80:95]
    global_load_dwordx4 a[0:3], v7, s[64:65] offset:-4096 sc1
    ds_read_b64_tr_b16 v[188:189], v227 offset:32768
    ds_read_b64_tr_b16 v[190:191], v227 offset:33280
    s_waitcnt lgkmcnt(4)
    v_mfma_f32_32x32x16_bf16 v[64:79], v[176:179], a[204:207], v[64:79]
    ds_read_b64_tr_b16 v[192:193], v210 offset:34816
    ds_read_b64_tr_b16 v[194:195], v210 offset:35328
    v_mfma_f32_32x32x16_bf16 v[80:95], v[180:183], a[204:207], v[80:95]
    global_load_dwordx4 a[4:7], v7, s[64:65] offset:-3072 sc1
    ds_read_b64_tr_b16 v[196:197], v227 offset:34816
    ds_read_b64_tr_b16 v[198:199], v227 offset:35328
    v_mov_b32 v240, -1
    s_waitcnt lgkmcnt(4)
    v_mfma_f32_32x32x16_bf16 v[64:79], v[184:187], a[208:211], v[64:79]
    ds_read_b64_tr_b16 v[176:177], v210 offset:36864
    ds_read_b64_tr_b16 v[178:179], v210 offset:37376
    v_mfma_f32_32x32x16_bf16 v[80:95], v[188:191], a[208:211], v[80:95]
    global_load_dwordx4 a[8:11], v7, s[64:65] offset:-2048 sc1
    ds_read_b64_tr_b16 v[180:181], v227 offset:36864
    ds_read_b64_tr_b16 v[182:183], v227 offset:37376
    v_mov_b32 v241, -1
    s_waitcnt lgkmcnt(4)
    v_mfma_f32_32x32x16_bf16 v[64:79], v[192:195], a[212:215], v[64:79]
    ds_read_b64_tr_b16 v[184:185], v210 offset:38912
    ds_read_b64_tr_b16 v[186:187], v210 offset:39424
    v_mfma_f32_32x32x16_bf16 v[80:95], v[196:199], a[212:215], v[80:95]
    global_load_dwordx4 a[12:15], v7, s[64:65] offset:-1024 sc1
    ds_read_b64_tr_b16 v[188:189], v227 offset:38912
    ds_read_b64_tr_b16 v[190:191], v227 offset:39424
    v_mov_b32 v242, -1
    s_waitcnt lgkmcnt(4)
    v_mfma_f32_32x32x16_bf16 v[64:79], v[176:179], a[216:219], v[64:79]
    ds_read_b64_tr_b16 v[192:193], v210 offset:40960
    ds_read_b64_tr_b16 v[194:195], v210 offset:41472
    v_mfma_f32_32x32x16_bf16 v[80:95], v[180:183], a[216:219], v[80:95]
    global_load_dwordx4 a[16:19], v7, s[64:65] offset:0 sc1
    ds_read_b64_tr_b16 v[196:197], v227 offset:40960
    ds_read_b64_tr_b16 v[198:199], v227 offset:41472
    v_mov_b32 v243, -1
    s_waitcnt lgkmcnt(4)
    v_mfma_f32_32x32x16_bf16 v[64:79], v[184:187], a[220:223], v[64:79]
    ds_read_b64_tr_b16 v[176:177], v210 offset:43008
    ds_read_b64_tr_b16 v[178:179], v210 offset:43520
    v_mfma_f32_32x32x16_bf16 v[80:95], v[188:191], a[220:223], v[80:95]
    global_load_dwordx4 a[20:23], v7, s[64:65] offset:1024 sc1
    ds_read_b64_tr_b16 v[180:181], v227 offset:43008
    ds_read_b64_tr_b16 v[182:183], v227 offset:43520
    v_mov_b32 v246, 0
    s_waitcnt lgkmcnt(4)
    v_mfma_f32_32x32x16_bf16 v[64:79], v[192:195], a[224:227], v[64:79]
    ds_read_b64_tr_b16 v[184:185], v210 offset:45056
    ds_read_b64_tr_b16 v[186:187], v210 offset:45568
    v_mfma_f32_32x32x16_bf16 v[80:95], v[196:199], a[224:227], v[80:95]
    global_load_dwordx4 a[24:27], v7, s[64:65] offset:2048 sc1
    ds_read_b64_tr_b16 v[188:189], v227 offset:45056
    ds_read_b64_tr_b16 v[190:191], v227 offset:45568
    v_mov_b32 v247, 0
    s_waitcnt lgkmcnt(4)
    v_mfma_f32_32x32x16_bf16 v[64:79], v[176:179], a[228:231], v[64:79]
    ds_read_b64_tr_b16 v[192:193], v210 offset:47104
    ds_read_b64_tr_b16 v[194:195], v210 offset:47616
    v_mfma_f32_32x32x16_bf16 v[80:95], v[180:183], a[228:231], v[80:95]
    global_load_dwordx4 a[28:31], v7, s[64:65] offset:3072 sc1
    v_add_u32 v7, 0x2000, v7
    ds_read_b64_tr_b16 v[196:197], v227 offset:47104
    ds_read_b64_tr_b16 v[198:199], v227 offset:47616
    s_waitcnt lgkmcnt(4)
    v_mfma_f32_32x32x16_bf16 v[64:79], v[184:187], a[232:235], v[64:79]
    ds_read_b64_tr_b16 v[176:177], v210 offset:49152
    ds_read_b64_tr_b16 v[178:179], v210 offset:49664
    v_mfma_f32_32x32x16_bf16 v[80:95], v[188:191], a[232:235], v[80:95]
    global_load_dwordx4 a[32:35], v7, s[64:65] offset:-4096 sc1
    ds_read_b64_tr_b16 v[180:181], v227 offset:49152
    ds_read_b64_tr_b16 v[182:183], v227 offset:49664
    s_waitcnt lgkmcnt(4)
    v_mfma_f32_32x32x16_bf16 v[64:79], v[192:195], a[236:239], v[64:79]
    ds_read_b64_tr_b16 v[184:185], v210 offset:51200
    ds_read_b64_tr_b16 v[186:187], v210 offset:51712
    v_mfma_f32_32x32x16_bf16 v[80:95], v[196:199], a[236:239], v[80:95]
    global_load_dwordx4 a[36:39], v7, s[64:65] offset:-3072 sc1
    ds_read_b64_tr_b16 v[188:189], v227 offset:51200
    ds_read_b64_tr_b16 v[190:191], v227 offset:51712
    s_waitcnt lgkmcnt(4)
    v_mfma_f32_32x32x16_bf16 v[64:79], v[176:179], a[240:243], v[64:79]
    ds_read_b64_tr_b16 v[192:193], v210 offset:53248
    ds_read_b64_tr_b16 v[194:195], v210 offset:53760
    v_mfma_f32_32x32x16_bf16 v[80:95], v[180:183], a[240:243], v[80:95]
    global_load_dwordx4 a[40:43], v7, s[64:65] offset:-2048 sc1
    ds_read_b64_tr_b16 v[196:197], v227 offset:53248
    ds_read_b64_tr_b16 v[198:199], v227 offset:53760
    s_waitcnt lgkmcnt(4)
    v_mfma_f32_32x32x16_bf16 v[64:79], v[184:187], a[244:247], v[64:79]
    ds_read_b64_tr_b16 v[176:177], v210 offset:55296
    ds_read_b64_tr_b16 v[178:179], v210 offset:55808
    v_mfma_f32_32x32x16_bf16 v[80:95], v[188:191], a[244:247], v[80:95]
    global_load_dwordx4 a[44:47], v7, s[64:65] offset:-1024 sc1
    ds_read_b64_tr_b16 v[180:181], v227 offset:55296
    ds_read_b64_tr_b16 v[182:183], v227 offset:55808
    s_waitcnt lgkmcnt(4)
    v_mfma_f32_32x32x16_bf16 v[64:79], v[192:195], a[248:251], v[64:79]
    v_mfma_f32_32x32x16_bf16 v[80:95], v[196:199], a[248:251], v[80:95]
    s_waitcnt lgkmcnt(0)
    v_mfma_f32_32x32x16_bf16 v[64:79], v[176:179], a[252:255], v[64:79]
    v_mfma_f32_32x32x16_bf16 v[80:95], v[180:183], a[252:255], v[80:95]
    s_branch L_f_p2done
L_f_late:
L_f_pad7:
    s_cbranch_execz L_f_pad11
    s_mov_b32 s44, 0
    s_waitcnt lgkmcnt(4)
    v_mfma_f32_32x32x16_bf16 v[64:79], v[192:195], a[200:203], v[64:79]
    ds_read_b64_tr_b16 v[184:185], v210 offset:32768
    ds_read_b64_tr_b16 v[186:187], v210 offset:33280
    v_mfma_f32_32x32x16_bf16 v[80:95], v[196:199], a[200:203], v[80:95]
    ds_read_b64_tr_b16 v[188:189], v227 offset:32768
L_f_pad8:
    s_cbranch_execz L_f_pad12
    ds_read_b64_tr_b16 v[190:191], v227 offset:33280
    s_waitcnt lgkmcnt(4)
    v_mfma_f32_32x32x16_bf16 v[64:79], v[176:179], a[204:207], v[64:79]
    ds_read_b64_tr_b16 v[192:193], v210 offset:34816
    ds_read_b64_tr_b16 v[194:195], v210 offset:35328
    v_mfma_f32_32x32x16_bf16 v[80:95], v[180:183], a[204:207], v[80:95]
    ds_read_b64_tr_b16 v[196:197], v227 offset:34816
    ds_read_b64_tr_b16 v[198:199], v227 offset:35328
    v_mov_b32 v240, -1
    s_waitcnt lgkmcnt(4)
    v_mfma_f32_32x32x16_bf16 v[64:79], v[184:187], a[208:211], v[64:79]
    ds_read_b64_tr_b16 v[176:177], v210 offset:36864
    ds_read_b64_tr_b16 v[178:179], v210 offset:37376
    v_mfma_f32_32x32x16_bf16 v[80:95], v[188:191], a[208:211], v[80:95]
    ds_read_b64_tr_b16 v[180:181], v227 offset:36864
    ds_read_b64_tr_b16 v[182:183], v227 offset:37376
    v_mov_b32 v241, -1
    s_waitcnt lgkmcnt(4)
    v_mfma_f32_32x32x16_bf16 v[64:79], v[192:195], a[212:215], v[64:79]
    ds_read_b64_tr_b16 v[184:185], v210 offset:38912
    ds_read_b64_tr_b16 v[186:187], v210 offset:39424
    v_mfma_f32_32x32x16_bf16 v[80:95], v[196:199], a[212:215], v[80:95]
    ds_read_b64_tr_b16 v[188:189], v227 offset:38912
    ds_read_b64_tr_b16 v[190:191], v227 offset:39424
    v_mov_b32 v242, -1
    s_waitcnt lgkmcnt(4)
    v_mfma_f32_32x32x16_bf16 v[64:79], v[176:179], a[216:219], v[64:79]
    ds_read_b64_tr_b16 v[192:193], v210 offset:40960
    ds_read_b64_tr_b16 v[194:195], v210 offset:41472
    v_mfma_f32_32x32x16_bf16 v[80:95], v[180:183], a[216:219], v[80:95]
    buffer_load_dword v13, v14, s[16:19], 0 offen sc1
    ds_read_b64_tr_b16 v[196:197], v227 offset:40960
    ds_read_b64_tr_b16 v[198:199], v227 offset:41472
    v_mov_b32 v243, -1
    s_waitcnt lgkmcnt(4)
    v_mfma_f32_32x32x16_bf16 v[64:79], v[184:187], a[220:223], v[64:79]
    ds_read_b64_tr_b16 v[176:177], v210 offset:43008
    ds_read_b64_tr_b16 v[178:179], v210 offset:43520
    v_mfma_f32_32x32x16_bf16 v[80:95], v[188:191], a[220:223], v[80:95]
    ds_read_b64_tr_b16 v[180:181], v227 offset:43008
    ds_read_b64_tr_b16 v[182:183], v227 offset:43520
    v_mov_b32 v246, 0
    s_waitcnt lgkmcnt(4)
    v_mfma_f32_32x32x16_bf16 v[64:79], v[192:195], a[224:227], v[64:79]
    ds_read_b64_tr_b16 v[184:185], v210 offset:45056
    ds_read_b64_tr_b16 v[186:187], v210 offset:45568
    v_mfma_f32_32x32x16_bf16 v[80:95], v[196:199], a[224:227], v[80:95]
    ds_read_b64_tr_b16 v[188:189], v227 offset:45056
    ds_read_b64_tr_b16 v[190:191], v227 offset:45568
    v_mov_b32 v247, 0
    s_waitcnt lgkmcnt(4)
    v_mfma_f32_32x32x16_bf16 v[64:79], v[176:179], a[228:231], v[64:79]
    ds_read_b64_tr_b16 v[192:193], v210 offset:47104
    ds_read_b64_tr_b16 v[194:195], v210 offset:47616
    v_mfma_f32_32x32x16_bf16 v[80:95], v[180:183], a[228:231], v[80:95]
    ds_read_b64_tr_b16 v[196:197], v227 offset:47104
    ds_read_b64_tr_b16 v[198:199], v227 offset:47616
    s_waitcnt lgkmcnt(4)
    v_mfma_f32_32x32x16_bf16 v[64:79], v[184:187], a[232:235], v[64:79]
    ds_read_b64_tr_b16 v[176:177], v210 offset:49152
    ds_read_b64_tr_b16 v[178:179], v210 offset:49664
    v_mfma_f32_32x32x16_bf16 v[80:95], v[188:191], a[232:235], v[80:95]
    ds_read_b64_tr_b16 v[180:181], v227 offset:49152
    ds_read_b64_tr_b16 v[182:183], v227 offset:49664
    s_waitcnt lgkmcnt(4)
    v_mfma_f32_32x32x16_bf16 v[64:79], v[192:195], a[236:239], v[64:79]
    ds_read_b64_tr_b16 v[184:185], v210 offset:51200
    ds_read_b64_tr_b16 v[186:187], v210 offset:51712
    v_mfma_f32_32x32x16_bf16 v[80:95], v[196:199], a[236:239], v[80:95]
    ds_read_b64_tr_b16 v[188:189], v227 offset:51200
    ds_read_b64_tr_b16 v[190:191], v227 offset:51712
    s_waitcnt lgkmcnt(4)
    v_mfma_f32_32x32x16_bf16 v[64:79], v[176:179], a[240:243], v[64:79]
    ds_read_b64_tr_b16 v[192:193], v210 offset:53248
    ds_read_b64_tr_b16 v[194:195], v210 offset:53760
    v_mfma_f32_32x32x16_bf16 v[80:95], v[180:183], a[240:243], v[80:95]
    ds_read_b64_tr_b16 v[196:197], v227 offset:53248
    ds_read_b64_tr_b16 v[198:199], v227 offset:53760
    s_waitcnt lgkmcnt(4)
    v_mfma_f32_32x32x16_bf16 v[64:79], v[184:187], a[244:247], v[64:79]
    ds_read_b64_tr_b16 v[176:177], v210 offset:55296
    ds_read_b64_tr_b16 v[178:179], v210 offset:55808
    v_mfma_f32_32x32x16_bf16 v[80:95], v[188:191], a[244:247], v[80:95]
    ds_read_b64_tr_b16 v[180:181], v227 offset:55296
    ds_read_b64_tr_b16 v[182:183], v227 offset:55808
    s_waitcnt lgkmcnt(4)
    v_mfma_f32_32x32x16_bf16 v[64:79], v[192:195], a[248:251], v[64:79]
    v_mfma_f32_32x32x16_bf16 v[80:95], v[196:199], a[248:251], v[80:95]
    s_waitcnt lgkmcnt(0)
    v_mfma_f32_32x32x16_bf16 v[64:79], v[176:179], a[252:255], v[64:79]
    v_mfma_f32_32x32x16_bf16 v[80:95], v[180:183], a[252:255], v[80:95]
L_f_p2done:
L_f_pad9:
    s_cbranch_execz L_f_pad13
    s_mov_b32 s42, 0x3e8b97f6
    s_nop 9
    v_mul_f32 v64, s42, v64
    v_mul_f32 v65, s42, v65
    v_mul_f32 v66, s42, v66
    v_mul_f32 v67, s42, v67
    v_mul_f32 v68, s42, v68
    v_mul_f32 v69, s42, v69
    v_mul_f32 v70, s42, v70
    v_mul_f32 v71, s42, v71
    v_mul_f32 v72, s42, v72
    v_mul_f32 v73, s42, v73
    v_mul_f32 v74, s42, v74
    v_mul_f32 v75, s42, v75
    v_mul_f32 v76, s42, v76
    v_mul_f32 v77, s42, v77
    v_mul_f32 v78, s42, v78
    v_mul_f32 v79, s42, v79
    v_cvt_pk_bf16_f32 v56, v64, v65
    v_cvt_pk_bf16_f32 v57, v66, v67
    v_cvt_pk_bf16_f32 v58, v68, v69
    v_cvt_pk_bf16_f32 v59, v70, v71
    v_cvt_pk_bf16_f32 v60, v72, v73
    v_cvt_pk_bf16_f32 v61, v74, v75
    s_mov_b64 exec, 0xffffffff
    v_cvt_pk_bf16_f32 v62, v76, v77
    v_cvt_pk_bf16_f32 v63, v78, v79
    s_mov_b64 exec, -1
    ds_write_b128 v11, v[56:59]
    ds_write_b128 v11, v[60:63] offset:1024
    s_cmp_eq_u32 s44, 1
    s_cbranch_scc1 L_f_havekv
    s_waitcnt vmcnt(0)
    s_mov_b32 s35, 0
L_f_pollKV:
    v_cmp_ne_u32 vcc, s67, v13
    s_cbranch_vccz L_f_pollKV_done
    buffer_load_dword v13, v14, s[16:19], 0 offen sc1
    s_add_u32 s35, s35, 1
    s_cmp_lt_u32 s35, 262144
    s_waitcnt vmcnt(0)
    s_cbranch_scc1 L_f_pollKV
L_f_pollKV_done:
    global_load_dwordx4 a[0:3], v7, s[64:65] offset:-4096 sc1
    global_load_dwordx4 a[4:7], v7, s[64:65] offset:-3072 sc1
    global_load_dwordx4 a[8:11], v7, s[64:65] offset:-2048 sc1
    global_load_dwordx4 a[12:15], v7, s[64:65] offset:-1024 sc1
    global_load_dwordx4 a[16:19], v7, s[64:65] offset:0 sc1
    global_load_dwordx4 a[20:23], v7, s[64:65] offset:1024 sc1
    global_load_dwordx4 a[24:27], v7, s[64:65] offset:2048 sc1
    global_load_dwordx4 a[28:31], v7, s[64:65] offset:3072 sc1
    v_add_u32 v7, 0x2000, v7
    global_load_dwordx4 a[32:35], v7, s[64:65] offset:-4096 sc1
    global_load_dwordx4 a[36:39], v7, s[64:65] offset:-3072 sc1
    global_load_dwordx4 a[40:43], v7, s[64:65] offset:-2048 sc1
    global_load_dwordx4 a[44:47], v7, s[64:65] offset:-1024 sc1
L_f_havekv:
    v_mov_b32 v3, v92
    s_mov_b32 s42, 0x3fb8aa3b
    s_mov_b32 s54, 0x358637bd
    v_permlane32_swap_b32 v92, v3
    v_mul_f32 v3, 0xbfb8aa3b, v3
    v_exp_f32 v3, v3
    s_waitcnt lgkmcnt(0)
    s_barrier
    ds_read_b128 v[32:35], v224 offset:0
    ds_read_b128 v[36:39], v224 offset:1024
    ds_read_b128 v[40:43], v225 offset:0
    ds_read_b128 v[44:47], v225 offset:1024
    ds_read_b128 v[48:51], v226 offset:0
    ds_read_b128 v[52:55], v226 offset:1024
    v_add_f32 v3, 1.0, v3
    v_rcp_f32 v10, v3
    v_mul_f32 v192, s42, v80
    v_mul_f32 v193, s42, v81
    v_mul_f32 v194, s42, v82
    v_mul_f32 v195, s42, v83
    v_mul_f32 v196, s42, v84
    v_mul_f32 v197, s42, v85
    v_mul_f32 v198, s42, v86
    v_mul_f32 v199, s42, v87
    v_exp_f32_e64 v192, v192 clamp
    v_exp_f32_e64 v193, v193 clamp
    v_exp_f32_e64 v194, v194 clamp
    v_exp_f32_e64 v195, v195 clamp
    v_exp_f32_e64 v196, v196 clamp
    v_exp_f32_e64 v197, v197 clamp
    v_exp_f32_e64 v198, v198 clamp
    v_exp_f32_e64 v199, v199 clamp
    v_max_f32 v80, s54, v80
    v_max_f32 v81, s54, v81
    v_max_f32 v82, s54, v82
    v_max_f32 v83, s54, v83
    v_max_f32 v84, s54, v84
    v_max_f32 v85, s54, v85
    v_max_f32 v86, s54, v86
    v_max_f32 v87, s54, v87
    v_add_f32 v80, v80, v192
    v_add_f32 v81, v81, v193
    v_add_f32 v82, v82, v194
    v_add_f32 v83, v83, v195
    v_add_f32 v84, v84, v196
    v_add_f32 v85, v85, v197
    v_add_f32 v86, v86, v198
    v_add_f32 v87, v87, v199
    v_mul_f32 v192, s42, v88
    v_mul_f32 v193, s42, v89
    v_mul_f32 v194, s42, v90
    v_mul_f32 v195, s42, v91
    v_mul_f32 v196, s42, v92
    v_mul_f32 v197, s42, v93
    v_mul_f32 v198, s42, v94
    v_mul_f32 v199, s42, v95
    v_exp_f32_e64 v192, v192 clamp
    v_exp_f32_e64 v193, v193 clamp
    v_exp_f32_e64 v194, v194 clamp
    v_exp_f32_e64 v195, v195 clamp
    v_exp_f32_e64 v196, v196 clamp
    v_exp_f32_e64 v197, v197 clamp
    v_exp_f32_e64 v198, v198 clamp
    v_exp_f32_e64 v199, v199 clamp
    v_max_f32 v88, s54, v88
    v_max_f32 v89, s54, v89
    v_max_f32 v90, s54, v90
    v_max_f32 v91, s54, v91
    v_max_f32 v92, s54, v92
    v_max_f32 v93, s54, v93
    v_max_f32 v94, s54, v94
    v_max_f32 v95, s54, v95
    v_add_f32 v88, v88, v192
    v_add_f32 v89, v89, v193
    v_add_f32 v90, v90, v194
    v_add_f32 v91, v91, v195
    v_add_f32 v92, v92, v196
    v_add_f32 v93, v93, v197
    v_add_f32 v94, v94, v198
    v_add_f32 v95, v95, v199
    v_cvt_pk_bf16_f32 v232, v80, v81
    v_cvt_pk_bf16_f32 v233, v82, v83
    v_cvt_pk_bf16_f32 v234, v84, v85
    v_cvt_pk_bf16_f32 v235, v86, v87
    v_cvt_pk_bf16_f32 v236, v88, v89
    v_cvt_pk_bf16_f32 v237, v90, v91
    s_mov_b64 exec, 0xffffffff
    v_cvt_pk_bf16_f32 v238, v92, v93
    v_cvt_pk_bf16_f32 v239, v94, v95
    s_mov_b64 exec, -1
    s_waitcnt vmcnt(10) lgkmcnt(0)
    v_mfma_f32_32x32x16_bf16 v[64:79], a[0:3], v[32:35], 0
    v_mfma_f32_32x32x16_bf16 v[64:79], a[4:7], v[36:39], v[64:79]
    s_nop 10
    v_mfma_f32_32x32x16_bf16 v[80:95], a[0:3], v[40:43], 0
    global_load_dwordx4 a[48:51], v7, s[64:65] offset:0 sc1
    v_exp_f32 v64, v64
    v_exp_f32 v65, v65
    v_exp_f32 v66, v66
    v_exp_f32 v67, v67
    v_mfma_f32_32x32x16_bf16 v[80:95], a[4:7], v[44:47], v[80:95]
    v_cvt_pk_bf16_f32 v96, v64, v65
    v_cvt_pk_bf16_f32 v97, v66, v67
    v_exp_f32 v68, v68
    v_exp_f32 v69, v69
    v_exp_f32 v70, v70
    v_exp_f32 v71, v71
    s_waitcnt vmcnt(9)
    v_cvt_pk_bf16_f32 v98, v68, v69
    v_cvt_pk_bf16_f32 v99, v70, v71
    v_exp_f32 v72, v72
    v_exp_f32 v73, v73
    v_exp_f32 v74, v74
    v_exp_f32 v75, v75
    v_mfma_f32_32x32x16_bf16 v[104:119], a[8:11], v[96:99], 0
    global_load_dwordx4 a[52:55], v7, s[64:65] offset:1024 sc1
    v_cvt_pk_bf16_f32 v100, v72, v73
    v_cvt_pk_bf16_f32 v101, v74, v75
    v_exp_f32 v76, v76
    v_exp_f32 v77, v77
    v_exp_f32 v78, v78
    v_exp_f32 v79, v79
    v_cvt_pk_bf16_f32 v102, v76, v77
    v_cvt_pk_bf16_f32 v103, v78, v79
    v_mfma_f32_32x32x16_bf16 v[64:79], a[0:3], v[48:51], 0
    v_exp_f32 v80, v80
    v_exp_f32 v81, v81
    v_exp_f32 v82, v82
    v_exp_f32 v83, v83
    v_mfma_f32_32x32x16_bf16 v[64:79], a[4:7], v[52:55], v[64:79]
    global_load_dwordx4 a[56:59], v7, s[64:65] offset:2048 sc1
    v_cvt_pk_bf16_f32 v96, v80, v81
    v_cvt_pk_bf16_f32 v97, v82, v83
    v_exp_f32 v84, v84
    v_exp_f32 v85, v85
    v_exp_f32 v86, v86
    v_exp_f32 v87, v87
    v_mfma_f32_32x32x16_bf16 v[104:119], a[12:15], v[100:103], v[104:119]
    v_cvt_pk_bf16_f32 v98, v84, v85
    v_cvt_pk_bf16_f32 v99, v86, v87
    v_exp_f32 v88, v88
    v_exp_f32 v89, v89
    v_exp_f32 v90, v90
    v_exp_f32 v91, v91
    v_mfma_f32_32x32x16_bf16 v[120:135], a[8:11], v[96:99], 0
    global_load_dwordx4 a[60:63], v7, s[64:65] offset:3072 sc1
    v_add_u32 v7, 0x2000, v7
    v_cvt_pk_bf16_f32 v100, v88, v89
    v_cvt_pk_bf16_f32 v101, v90, v91
    v_exp_f32 v92, v92
    v_exp_f32 v93, v93
    v_exp_f32 v94, v94
    v_exp_f32 v95, v95
    v_cvt_pk_bf16_f32 v102, v92, v93
    v_cvt_pk_bf16_f32 v103, v94, v95
    v_mfma_f32_32x32x16_bf16 v[80:95], a[0:3], v[56:59], 0
    v_exp_f32 v64, v64
    v_exp_f32 v65, v65
    v_exp_f32 v66, v66
    v_exp_f32 v67, v67
    v_mfma_f32_32x32x16_bf16 v[80:95], a[4:7], v[60:63], v[80:95]
    buffer_load_dword v13, v15, s[16:19], 0 offen sc1
    v_cvt_pk_bf16_f32 v96, v64, v65
    v_cvt_pk_bf16_f32 v97, v66, v67
    v_exp_f32 v68, v68
    v_exp_f32 v69, v69
    v_exp_f32 v70, v70
    v_exp_f32 v71, v71
    v_mfma_f32_32x32x16_bf16 v[120:135], a[12:15], v[100:103], v[120:135]
    s_waitcnt vmcnt(11)
    v_cvt_pk_bf16_f32 v98, v68, v69
    v_cvt_pk_bf16_f32 v99, v70, v71
    v_exp_f32 v72, v72
    v_exp_f32 v73, v73
    v_exp_f32 v74, v74
    v_exp_f32 v75, v75
    v_mfma_f32_32x32x16_bf16 v[136:151], a[8:11], v[96:99], 0
    v_cvt_pk_bf16_f32 v100, v72, v73
    v_cvt_pk_bf16_f32 v101, v74, v75
    v_exp_f32 v76, v76
    v_exp_f32 v77, v77
    v_exp_f32 v78, v78
    v_exp_f32 v79, v79
    v_cvt_pk_bf16_f32 v102, v76, v77
    v_cvt_pk_bf16_f32 v103, v78, v79
    v_mfma_f32_32x32x16_bf16 v[64:79], a[16:19], v[32:35], 0
    v_exp_f32 v80, v80
    v_exp_f32 v81, v81
    v_exp_f32 v82, v82
    v_exp_f32 v83, v83
    v_mfma_f32_32x32x16_bf16 v[64:79], a[20:23], v[36:39], v[64:79]
    v_cvt_pk_bf16_f32 v96, v80, v81
    v_cvt_pk_bf16_f32 v97, v82, v83
    v_exp_f32 v84, v84
    v_exp_f32 v85, v85
    v_exp_f32 v86, v86
    v_exp_f32 v87, v87
    v_mfma_f32_32x32x16_bf16 v[136:151], a[12:15], v[100:103], v[136:151]
    v_cvt_pk_bf16_f32 v98, v84, v85
    v_cvt_pk_bf16_f32 v99, v86, v87
    v_exp_f32 v88, v88
    v_exp_f32 v89, v89
    v_exp_f32 v90, v90
    v_exp_f32 v91, v91
    v_mfma_f32_32x32x16_bf16 v[152:167], a[8:11], v[96:99], 0
    v_cvt_pk_bf16_f32 v100, v88, v89
    v_cvt_pk_bf16_f32 v101, v90, v91
    v_exp_f32 v92, v92
    v_exp_f32 v93, v93
    v_exp_f32 v94, v94
    v_exp_f32 v95, v95
    v_cvt_pk_bf16_f32 v102, v92, v93
    v_cvt_pk_bf16_f32 v103, v94, v95
    v_mfma_f32_32x32x16_bf16 v[80:95], a[16:19], v[40:43], 0
    global_load_dwordx4 a[0:3], v7, s[64:65] offset:-4096 sc1
    v_exp_f32 v64, v64
    v_exp_f32 v65, v65
    v_exp_f32 v66, v66
    v_exp_f32 v67, v67
    v_mfma_f32_32x32x16_bf16 v[80:95], a[20:23], v[44:47], v[80:95]
    v_cvt_pk_bf16_f32 v96, v64, v65
    v_cvt_pk_bf16_f32 v97, v66, v67
    v_exp_f32 v68, v68
    v_exp_f32 v69, v69
    v_exp_f32 v70, v70
    v_exp_f32 v71, v71
    v_mfma_f32_32x32x16_bf16 v[152:167], a[12:15], v[100:103], v[152:167]
    s_waitcnt vmcnt(10)
    v_cvt_pk_bf16_f32 v98, v68, v69
    v_cvt_pk_bf16_f32 v99, v70, v71
    v_exp_f32 v72, v72
    v_exp_f32 v73, v73
    v_exp_f32 v74, v74
    v_exp_f32 v75, v75
    v_mfma_f32_32x32x16_bf16 v[104:119], a[24:27], v[96:99], v[104:119]
    global_load_dwordx4 a[4:7], v7, s[64:65] offset:-3072 sc1
    v_cvt_pk_bf16_f32 v100, v72, v73
    v_cvt_pk_bf16_f32 v101, v74, v75
    v_exp_f32 v76, v76
    v_exp_f32 v77, v77
    v_exp_f32 v78, v78
    v_exp_f32 v79, v79
    v_cvt_pk_bf16_f32 v102, v76, v77
    v_cvt_pk_bf16_f32 v103, v78, v79
    v_mfma_f32_32x32x16_bf16 v[64:79], a[16:19], v[48:51], 0
    s_waitcnt vmcnt(2)
    s_mov_b32 s35, 0
L_f_pollP:
    v_cmp_ne_u32 vcc, s67, v13
    s_cbranch_vccz L_f_pollP_done
    buffer_load_dword v13, v15, s[16:19], 0 offen sc1
    s_add_u32 s35, s35, 1
    s_cmp_lt_u32 s35, 262144
    s_waitcnt vmcnt(0)
    s_cbranch_scc1 L_f_pollP
L_f_pollP_done:
    v_exp_f32 v80, v80
    v_exp_f32 v81, v81
    v_exp_f32 v82, v82
    v_exp_f32 v83, v83
    v_mfma_f32_32x32x16_bf16 v[64:79], a[20:23], v[52:55], v[64:79]
    global_load_dwordx4 a[8:11], v7, s[64:65] offset:-2048 sc1
    v_cvt_pk_bf16_f32 v96, v80, v81
    v_cvt_pk_bf16_f32 v97, v82, v83
    v_exp_f32 v84, v84
    v_exp_f32 v85, v85
    v_exp_f32 v86, v86
    v_exp_f32 v87, v87
    v_mfma_f32_32x32x16_bf16 v[104:119], a[28:31], v[100:103], v[104:119]
    global_load_dwordx4 a[12:15], v7, s[64:65] offset:-1024 sc1
    v_cvt_pk_bf16_f32 v98, v84, v85
    v_cvt_pk_bf16_f32 v99, v86, v87
    v_exp_f32 v88, v88
    v_exp_f32 v89, v89
    v_exp_f32 v90, v90
    v_exp_f32 v91, v91
    v_mfma_f32_32x32x16_bf16 v[120:135], a[24:27], v[96:99], v[120:135]
    global_load_dwordx4 v[168:171], v8, s[64:65] offset:-4096 sc1
    v_cvt_pk_bf16_f32 v100, v88, v89
    v_cvt_pk_bf16_f32 v101, v90, v91
    v_exp_f32 v92, v92
    v_exp_f32 v93, v93
    v_exp_f32 v94, v94
    v_exp_f32 v95, v95
    v_cvt_pk_bf16_f32 v102, v92, v93
    v_cvt_pk_bf16_f32 v103, v94, v95
    v_mfma_f32_32x32x16_bf16 v[80:95], a[16:19], v[56:59], 0
    v_exp_f32 v64, v64
    v_exp_f32 v65, v65
    v_exp_f32 v66, v66
    v_exp_f32 v67, v67
    v_mfma_f32_32x32x16_bf16 v[80:95], a[20:23], v[60:63], v[80:95]
    global_load_dwordx4 v[172:175], v8, s[64:65] offset:-3072 sc1
    v_cvt_pk_bf16_f32 v96, v64, v65
    v_cvt_pk_bf16_f32 v97, v66, v67
    v_exp_f32 v68, v68
    v_exp_f32 v69, v69
    v_exp_f32 v70, v70
    v_exp_f32 v71, v71
    v_mfma_f32_32x32x16_bf16 v[120:135], a[28:31], v[100:103], v[120:135]
    global_load_dwordx4 v[176:179], v8, s[64:65] offset:-2048 sc1
    v_cvt_pk_bf16_f32 v98, v68, v69
    v_cvt_pk_bf16_f32 v99, v70, v71
    v_exp_f32 v72, v72
    v_exp_f32 v73, v73
    v_exp_f32 v74, v74
    v_exp_f32 v75, v75
    v_mfma_f32_32x32x16_bf16 v[136:151], a[24:27], v[96:99], v[136:151]
    global_load_dwordx4 v[180:183], v8, s[64:65] offset:-1024 sc1
    v_cvt_pk_bf16_f32 v100, v72, v73
    v_cvt_pk_bf16_f32 v101, v74, v75
    v_exp_f32 v76, v76
    v_exp_f32 v77, v77
    v_exp_f32 v78, v78
    v_exp_f32 v79, v79
    v_cvt_pk_bf16_f32 v102, v76, v77
    v_cvt_pk_bf16_f32 v103, v78, v79
    v_mfma_f32_32x32x16_bf16 v[64:79], a[32:35], v[32:35], 0
    v_exp_f32 v80, v80
    v_exp_f32 v81, v81
    v_exp_f32 v82, v82
    v_exp_f32 v83, v83
    v_mfma_f32_32x32x16_bf16 v[64:79], a[36:39], v[36:39], v[64:79]
    global_load_dwordx4 v[184:187], v8, s[64:65] offset:0 sc1
    v_cvt_pk_bf16_f32 v96, v80, v81
    v_cvt_pk_bf16_f32 v97, v82, v83
    v_exp_f32 v84, v84
    v_exp_f32 v85, v85
    v_exp_f32 v86, v86
    v_exp_f32 v87, v87
    v_mfma_f32_32x32x16_bf16 v[136:151], a[28:31], v[100:103], v[136:151]
    global_load_dwordx4 v[188:191], v8, s[64:65] offset:1024 sc1
    v_cvt_pk_bf16_f32 v98, v84, v85
    v_cvt_pk_bf16_f32 v99, v86, v87
    v_exp_f32 v88, v88
    v_exp_f32 v89, v89
    v_exp_f32 v90, v90
    v_exp_f32 v91, v91
    v_mfma_f32_32x32x16_bf16 v[152:167], a[24:27], v[96:99], v[152:167]
    global_load_dwordx4 v[192:195], v8, s[64:65] offset:2048 sc1
    v_cvt_pk_bf16_f32 v100, v88, v89
    v_cvt_pk_bf16_f32 v101, v90, v91
    v_exp_f32 v92, v92
    v_exp_f32 v93, v93
    v_exp_f32 v94, v94
    v_exp_f32 v95, v95
    v_cvt_pk_bf16_f32 v102, v92, v93
    v_cvt_pk_bf16_f32 v103, v94, v95
    v_mfma_f32_32x32x16_bf16 v[80:95], a[32:35], v[40:43], 0
    v_exp_f32 v64, v64
    v_exp_f32 v65, v65
    v_exp_f32 v66, v66
    v_exp_f32 v67, v67
    v_mfma_f32_32x32x16_bf16 v[80:95], a[36:39], v[44:47], v[80:95]
    global_load_dwordx4 a[16:19], v7, s[64:65] offset:0 sc1
    v_cvt_pk_bf16_f32 v96, v64, v65
    v_cvt_pk_bf16_f32 v97, v66, v67
    v_exp_f32 v68, v68
    v_exp_f32 v69, v69
    v_exp_f32 v70, v70
    v_exp_f32 v71, v71
    v_mfma_f32_32x32x16_bf16 v[152:167], a[28:31], v[100:103], v[152:167]
    global_load_dwordx4 a[20:23], v7, s[64:65] offset:1024 sc1
    v_cvt_pk_bf16_f32 v98, v68, v69
    v_cvt_pk_bf16_f32 v99, v70, v71
    v_exp_f32 v72, v72
    v_exp_f32 v73, v73
    v_exp_f32 v74, v74
    v_exp_f32 v75, v75
    v_mfma_f32_32x32x16_bf16 v[104:119], a[40:43], v[96:99], v[104:119]
    global_load_dwordx4 a[24:27], v7, s[64:65] offset:2048 sc1
    v_cvt_pk_bf16_f32 v100, v72, v73
    v_cvt_pk_bf16_f32 v101, v74, v75
    v_exp_f32 v76, v76
    v_exp_f32 v77, v77
    v_exp_f32 v78, v78
    v_exp_f32 v79, v79
    v_cvt_pk_bf16_f32 v102, v76, v77
    v_cvt_pk_bf16_f32 v103, v78, v79
    v_mfma_f32_32x32x16_bf16 v[64:79], a[32:35], v[48:51], 0
    v_exp_f32 v80, v80
    v_exp_f32 v81, v81
    v_exp_f32 v82, v82
    v_exp_f32 v83, v83
    v_mfma_f32_32x32x16_bf16 v[64:79], a[36:39], v[52:55], v[64:79]
    global_load_dwordx4 a[28:31], v7, s[64:65] offset:3072 sc1
    v_add_u32 v7, 0x2000, v7
    v_cvt_pk_bf16_f32 v96, v80, v81
    v_cvt_pk_bf16_f32 v97, v82, v83
    v_exp_f32 v84, v84
    v_exp_f32 v85, v85
    v_exp_f32 v86, v86
    v_exp_f32 v87, v87
    v_mfma_f32_32x32x16_bf16 v[104:119], a[44:47], v[100:103], v[104:119]
    global_load_dwordx4 v[196:199], v8, s[64:65] offset:3072 sc1
    v_add_u32 v8, 0x2000, v8
    v_cvt_pk_bf16_f32 v98, v84, v85
    v_cvt_pk_bf16_f32 v99, v86, v87
    v_exp_f32 v88, v88
    v_exp_f32 v89, v89
    v_exp_f32 v90, v90
    v_exp_f32 v91, v91
    v_mfma_f32_32x32x16_bf16 v[120:135], a[40:43], v[96:99], v[120:135]
    global_load_dwordx4 v[200:203], v8, s[64:65] offset:-4096 sc1
    v_cvt_pk_bf16_f32 v100, v88, v89
    v_cvt_pk_bf16_f32 v101, v90, v91
    v_exp_f32 v92, v92
    v_exp_f32 v93, v93
    v_exp_f32 v94, v94
    v_exp_f32 v95, v95
    v_cvt_pk_bf16_f32 v102, v92, v93
    v_cvt_pk_bf16_f32 v103, v94, v95
    v_mfma_f32_32x32x16_bf16 v[80:95], a[32:35], v[56:59], 0
    v_exp_f32 v64, v64
    v_exp_f32 v65, v65
    v_exp_f32 v66, v66
    v_exp_f32 v67, v67
    v_mfma_f32_32x32x16_bf16 v[80:95], a[36:39], v[60:63], v[80:95]
    global_load_dwordx4 v[204:207], v8, s[64:65] offset:-3072 sc1
    v_cvt_pk_bf16_f32 v96, v64, v65
    v_cvt_pk_bf16_f32 v97, v66, v67
    v_exp_f32 v68, v68
    v_exp_f32 v69, v69
    v_exp_f32 v70, v70
    v_exp_f32 v71, v71
    v_mfma_f32_32x32x16_bf16 v[120:135], a[44:47], v[100:103], v[120:135]
    global_load_dwordx4 v[208:211], v8, s[64:65] offset:-2048 sc1
    v_cvt_pk_bf16_f32 v98, v68, v69
    v_cvt_pk_bf16_f32 v99, v70, v71
    v_exp_f32 v72, v72
    v_exp_f32 v73, v73
    v_exp_f32 v74, v74
    v_exp_f32 v75, v75
    v_mfma_f32_32x32x16_bf16 v[136:151], a[40:43], v[96:99], v[136:151]
    global_load_dwordx4 v[212:215], v8, s[64:65] offset:-1024 sc1
    v_cvt_pk_bf16_f32 v100, v72, v73
    v_cvt_pk_bf16_f32 v101, v74, v75
    v_exp_f32 v76, v76
    v_exp_f32 v77, v77
    v_exp_f32 v78, v78
    v_exp_f32 v79, v79
    v_cvt_pk_bf16_f32 v102, v76, v77
    v_cvt_pk_bf16_f32 v103, v78, v79
    v_mfma_f32_32x32x16_bf16 v[64:79], a[48:51], v[32:35], 0
    v_exp_f32 v80, v80
    v_exp_f32 v81, v81
    v_exp_f32 v82, v82
    v_exp_f32 v83, v83
    v_mfma_f32_32x32x16_bf16 v[64:79], a[52:55], v[36:39], v[64:79]
    global_load_dwordx4 v[216:219], v8, s[64:65] offset:0 sc1
    v_cvt_pk_bf16_f32 v96, v80, v81
    v_cvt_pk_bf16_f32 v97, v82, v83
    v_exp_f32 v84, v84
    v_exp_f32 v85, v85
    v_exp_f32 v86, v86
    v_exp_f32 v87, v87
    v_mfma_f32_32x32x16_bf16 v[136:151], a[44:47], v[100:103], v[136:151]
    global_load_dwordx4 v[220:223], v8, s[64:65] offset:1024 sc1
    v_cvt_pk_bf16_f32 v98, v84, v85
    v_cvt_pk_bf16_f32 v99, v86, v87
    v_exp_f32 v88, v88
    v_exp_f32 v89, v89
    v_exp_f32 v90, v90
    v_exp_f32 v91, v91
    v_mfma_f32_32x32x16_bf16 v[152:167], a[40:43], v[96:99], v[152:167]
    global_load_dwordx4 v[224:227], v8, s[64:65] offset:2048 sc1
    v_cvt_pk_bf16_f32 v100, v88, v89
    v_cvt_pk_bf16_f32 v101, v90, v91
    v_exp_f32 v92, v92
    v_exp_f32 v93, v93
    v_exp_f32 v94, v94
    v_exp_f32 v95, v95
    v_cvt_pk_bf16_f32 v102, v92, v93
    v_cvt_pk_bf16_f32 v103, v94, v95
    v_mfma_f32_32x32x16_bf16 v[80:95], a[48:51], v[40:43], 0
    v_exp_f32 v64, v64
    v_exp_f32 v65, v65
    v_exp_f32 v66, v66
    v_exp_f32 v67, v67
    v_mfma_f32_32x32x16_bf16 v[80:95], a[52:55], v[44:47], v[80:95]
    global_load_dwordx4 a[32:35], v7, s[64:65] offset:-4096 sc1
    v_cvt_pk_bf16_f32 v96, v64, v65
    v_cvt_pk_bf16_f32 v97, v66, v67
    v_exp_f32 v68, v68
    v_exp_f32 v69, v69
    v_exp_f32 v70, v70
    v_exp_f32 v71, v71
    v_mfma_f32_32x32x16_bf16 v[152:167], a[44:47], v[100:103], v[152:167]
    global_load_dwordx4 a[36:39], v7, s[64:65] offset:-3072 sc1
    v_cvt_pk_bf16_f32 v98, v68, v69
    v_cvt_pk_bf16_f32 v99, v70, v71
    v_exp_f32 v72, v72
    v_exp_f32 v73, v73
    v_exp_f32 v74, v74
    v_exp_f32 v75, v75
    v_mfma_f32_32x32x16_bf16 v[104:119], a[56:59], v[96:99], v[104:119]
    global_load_dwordx4 a[40:43], v7, s[64:65] offset:-2048 sc1
    v_cvt_pk_bf16_f32 v100, v72, v73
    v_cvt_pk_bf16_f32 v101, v74, v75
    v_exp_f32 v76, v76
    v_exp_f32 v77, v77
    v_exp_f32 v78, v78
    v_exp_f32 v79, v79
    v_cvt_pk_bf16_f32 v102, v76, v77
    v_cvt_pk_bf16_f32 v103, v78, v79
    v_mfma_f32_32x32x16_bf16 v[64:79], a[48:51], v[48:51], 0
    v_exp_f32 v80, v80
    v_exp_f32 v81, v81
    v_exp_f32 v82, v82
    v_exp_f32 v83, v83
    v_mfma_f32_32x32x16_bf16 v[64:79], a[52:55], v[52:55], v[64:79]
    global_load_dwordx4 a[44:47], v7, s[64:65] offset:-1024 sc1
    v_cvt_pk_bf16_f32 v96, v80, v81
    v_cvt_pk_bf16_f32 v97, v82, v83
    v_exp_f32 v84, v84
    v_exp_f32 v85, v85
    v_exp_f32 v86, v86
    v_exp_f32 v87, v87
    v_mfma_f32_32x32x16_bf16 v[104:119], a[60:63], v[100:103], v[104:119]
    global_load_dwordx4 v[228:231], v8, s[64:65] offset:3072 sc1
    v_cvt_pk_bf16_f32 v98, v84, v85
    v_cvt_pk_bf16_f32 v99, v86, v87
    v_exp_f32 v88, v88
    v_exp_f32 v89, v89
    v_exp_f32 v90, v90
    v_exp_f32 v91, v91
    v_mfma_f32_32x32x16_bf16 v[120:135], a[56:59], v[96:99], v[120:135]
    v_cvt_pk_bf16_f32 v100, v88, v89
    v_cvt_pk_bf16_f32 v101, v90, v91
    v_exp_f32 v92, v92
    v_exp_f32 v93, v93
    v_exp_f32 v94, v94
    v_exp_f32 v95, v95
    v_cvt_pk_bf16_f32 v102, v92, v93
    v_cvt_pk_bf16_f32 v103, v94, v95
    v_mfma_f32_32x32x16_bf16 v[80:95], a[48:51], v[56:59], 0
    v_exp_f32 v64, v64
    v_exp_f32 v65, v65
L_f_pad10:
    s_cbranch_execz L_f_tdone
    v_exp_f32 v66, v66
    v_exp_f32 v67, v67
    v_mfma_f32_32x32x16_bf16 v[80:95], a[52:55], v[60:63], v[80:95]
    buffer_store_dwordx4 v[240:243], v6, s[16:19], s61 offen offset:0 sc1
    v_cvt_pk_bf16_f32 v96, v64, v65
    v_cvt_pk_bf16_f32 v97, v66, v67
    v_exp_f32 v68, v68
    v_exp_f32 v69, v69
    v_exp_f32 v70, v70
    v_exp_f32 v71, v71
    v_mfma_f32_32x32x16_bf16 v[120:135], a[60:63], v[100:103], v[120:135]
    s_waitcnt vmcnt(27)
    v_cvt_pk_bf16_f32 v98, v68, v69
    v_cvt_pk_bf16_f32 v99, v70, v71
    v_exp_f32 v72, v72
    v_exp_f32 v73, v73
    v_exp_f32 v74, v74
    v_exp_f32 v75, v75
    v_mfma_f32_32x32x16_bf16 v[136:151], a[56:59], v[96:99], v[136:151]
    buffer_store_dwordx4 v[240:243], v6, s[16:19], s61 offen offset:1024 sc1
    v_cvt_pk_bf16_f32 v100, v72, v73
    v_cvt_pk_bf16_f32 v101, v74, v75
    v_exp_f32 v76, v76
    v_exp_f32 v77, v77
    v_exp_f32 v78, v78
    v_exp_f32 v79, v79
    v_cvt_pk_bf16_f32 v102, v76, v77
    v_cvt_pk_bf16_f32 v103, v78, v79
    v_mfma_f32_32x32x16_bf16 v[64:79], a[0:3], v[32:35], 0
    v_exp_f32 v80, v80
    v_exp_f32 v81, v81
    v_exp_f32 v82, v82
    v_exp_f32 v83, v83
    v_mfma_f32_32x32x16_bf16 v[64:79], a[4:7], v[36:39], v[64:79]
    global_load_dword v4, v17, s[76:77] offset:0
    v_cvt_pk_bf16_f32 v96, v80, v81
    v_cvt_pk_bf16_f32 v97, v82, v83
    v_exp_f32 v84, v84
    v_exp_f32 v85, v85
    v_exp_f32 v86, v86
    v_exp_f32 v87, v87
    v_mfma_f32_32x32x16_bf16 v[136:151], a[60:63], v[100:103], v[136:151]
    v_cvt_pk_bf16_f32 v98, v84, v85
    v_cvt_pk_bf16_f32 v99, v86, v87
    v_exp_f32 v88, v88
    v_exp_f32 v89, v89
    v_exp_f32 v90, v90
    v_exp_f32 v91, v91
    v_mfma_f32_32x32x16_bf16 v[152:167], a[56:59], v[96:99], v[152:167]
    global_load_dword v4, v17, s[76:77] offset:1664
    v_add_u32 v17, 3328, v17
    v_cvt_pk_bf16_f32 v100, v88, v89
    v_cvt_pk_bf16_f32 v101, v90, v91
    v_exp_f32 v92, v92
    v_exp_f32 v93, v93
    v_exp_f32 v94, v94
    v_exp_f32 v95, v95
    v_cvt_pk_bf16_f32 v102, v92, v93
    v_cvt_pk_bf16_f32 v103, v94, v95
    v_mfma_f32_32x32x16_bf16 v[80:95], a[0:3], v[40:43], 0
    v_exp_f32 v64, v64
    v_exp_f32 v65, v65
    v_exp_f32 v66, v66
    v_exp_f32 v67, v67
    v_mfma_f32_32x32x16_bf16 v[80:95], a[4:7], v[44:47], v[80:95]
    global_load_dwordx4 a[48:51], v7, s[64:65] offset:0 sc1
    v_cvt_pk_bf16_f32 v96, v64, v65
    v_cvt_pk_bf16_f32 v97, v66, v67
    v_exp_f32 v68, v68
    v_exp_f32 v69, v69
    v_exp_f32 v70, v70
    v_exp_f32 v71, v71
    v_mfma_f32_32x32x16_bf16 v[152:167], a[60:63], v[100:103], v[152:167]
    s_waitcnt vmcnt(29)
    v_cvt_pk_bf16_f32 v98, v68, v69
    v_cvt_pk_bf16_f32 v99, v70, v71
    v_exp_f32 v72, v72
    v_exp_f32 v73, v73
    v_exp_f32 v74, v74
    v_exp_f32 v75, v75
    v_mfma_f32_32x32x16_bf16 v[104:119], a[8:11], v[96:99], v[104:119]
    global_load_dwordx4 a[52:55], v7, s[64:65] offset:1024 sc1
    v_cvt_pk_bf16_f32 v100, v72, v73
    v_cvt_pk_bf16_f32 v101, v74, v75
    v_exp_f32 v76, v76
    v_exp_f32 v77, v77
    v_exp_f32 v78, v78
    v_exp_f32 v79, v79
    v_cvt_pk_bf16_f32 v102, v76, v77
    v_cvt_pk_bf16_f32 v103, v78, v79
    v_mfma_f32_32x32x16_bf16 v[64:79], a[0:3], v[48:51], 0
    s_waitcnt vmcnt(6)
    v_add_f32 v168, v168, v200
    v_add_f32 v169, v169, v201
    v_add_f32 v170, v170, v202
    v_add_f32 v171, v171, v203
    v_add_f32 v172, v172, v204
    v_add_f32 v173, v173, v205
    v_add_f32 v174, v174, v206
    v_add_f32 v175, v175, v207
    v_exp_f32 v80, v80
    v_exp_f32 v81, v81
    v_exp_f32 v82, v82
    v_exp_f32 v83, v83
    v_mfma_f32_32x32x16_bf16 v[64:79], a[4:7], v[52:55], v[64:79]
    global_load_dwordx4 a[56:59], v7, s[64:65] offset:2048 sc1
    v_add_f32 v176, v176, v208
    v_add_f32 v177, v177, v209
    v_add_f32 v178, v178, v210
    v_add_f32 v179, v179, v211
    v_add_f32 v180, v180, v212
    v_add_f32 v181, v181, v213
    v_add_f32 v182, v182, v214
    v_add_f32 v183, v183, v215
    v_cvt_pk_bf16_f32 v96, v80, v81
    v_cvt_pk_bf16_f32 v97, v82, v83
    v_exp_f32 v84, v84
    v_exp_f32 v85, v85
    v_exp_f32 v86, v86
    v_exp_f32 v87, v87
    v_mfma_f32_32x32x16_bf16 v[104:119], a[12:15], v[100:103], v[104:119]
    v_add_f32 v184, v184, v216
    v_add_f32 v185, v185, v217
    v_add_f32 v186, v186, v218
    v_add_f32 v187, v187, v219
    v_add_f32 v188, v188, v220
    v_add_f32 v189, v189, v221
    v_add_f32 v190, v190, v222
    v_add_f32 v191, v191, v223
    v_cvt_pk_bf16_f32 v98, v84, v85
    v_cvt_pk_bf16_f32 v99, v86, v87
    v_exp_f32 v88, v88
    v_exp_f32 v89, v89
    v_exp_f32 v90, v90
    v_exp_f32 v91, v91
    v_mfma_f32_32x32x16_bf16 v[120:135], a[8:11], v[96:99], v[120:135]
    global_load_dwordx4 a[60:63], v7, s[64:65] offset:3072 sc1
    v_add_u32 v7, 0x2000, v7
    v_add_f32 v192, v192, v224
    v_add_f32 v193, v193, v225
    v_add_f32 v194, v194, v226
    v_add_f32 v195, v195, v227
    v_add_f32 v196, v196, v228
    v_add_f32 v197, v197, v229
    v_add_f32 v198, v198, v230
    v_add_f32 v199, v199, v231
    v_cvt_pk_bf16_f32 v100, v88, v89
    v_cvt_pk_bf16_f32 v101, v90, v91
    v_exp_f32 v92, v92
    v_exp_f32 v93, v93
    v_exp_f32 v94, v94
    v_exp_f32 v95, v95
    v_cvt_pk_bf16_f32 v102, v92, v93
    v_cvt_pk_bf16_f32 v103, v94, v95
    v_mfma_f32_32x32x16_bf16 v[80:95], a[0:3], v[56:59], 0
    v_add_f32 v168, v168, v184
    v_add_f32 v169, v169, v185
    v_add_f32 v170, v170, v186
    v_add_f32 v171, v171, v187
    v_add_f32 v172, v172, v188
    v_add_f32 v173, v173, v189
    v_add_f32 v174, v174, v190
    v_add_f32 v175, v175, v191
    v_exp_f32 v64, v64
    v_exp_f32 v65, v65
    v_exp_f32 v66, v66
    v_exp_f32 v67, v67
    v_mfma_f32_32x32x16_bf16 v[80:95], a[4:7], v[60:63], v[80:95]
    global_load_dword v4, v17, s[76:77] offset:0
    v_add_u32 v17, 1280, v17
    v_add_f32 v176, v176, v192
    v_add_f32 v177, v177, v193
    v_add_f32 v178, v178, v194
    v_add_f32 v179, v179, v195
    v_add_f32 v180, v180, v196
    v_add_f32 v181, v181, v197
    v_add_f32 v182, v182, v198
    v_add_f32 v183, v183, v199
    v_cvt_pk_bf16_f32 v96, v64, v65
    v_cvt_pk_bf16_f32 v97, v66, v67
    v_exp_f32 v68, v68
    v_exp_f32 v69, v69
    v_exp_f32 v70, v70
    v_exp_f32 v71, v71
    v_mfma_f32_32x32x16_bf16 v[120:135], a[12:15], v[100:103], v[120:135]
    v_add_f32 v168, v168, v176
    v_add_f32 v169, v169, v177
    v_add_f32 v170, v170, v178
    v_add_f32 v171, v171, v179
    v_add_f32 v172, v172, v180
    v_add_f32 v173, v173, v181
    v_add_f32 v174, v174, v182
    v_add_f32 v175, v175, v183
    v_cvt_pk_bf16_f32 v98, v68, v69
    v_cvt_pk_bf16_f32 v99, v70, v71
    v_exp_f32 v72, v72
    v_exp_f32 v73, v73
    v_exp_f32 v74, v74
    v_exp_f32 v75, v75
    v_mfma_f32_32x32x16_bf16 v[136:151], a[8:11], v[96:99], v[136:151]
    global_load_dword v4, v17, s[76:77] offset:0
    v_add_f32 v168, v168, v172
    v_add_f32 v169, v169, v173
    v_add_f32 v170, v170, v174
    v_add_f32 v171, v171, v175
    v_cvt_pk_bf16_f32 v100, v72, v73
    v_cvt_pk_bf16_f32 v101, v74, v75
    v_exp_f32 v76, v76
    v_exp_f32 v77, v77
    v_exp_f32 v78, v78
    v_exp_f32 v79, v79
    v_cvt_pk_bf16_f32 v102, v76, v77
    v_cvt_pk_bf16_f32 v103, v78, v79
    v_mfma_f32_32x32x16_bf16 v[64:79], a[16:19], v[32:35], 0
    s_add_u32 m0, s60, 49152
    v_cvt_pk_bf16_f32 v30, v168, v169
    v_cvt_pk_bf16_f32 v31, v170, v171
    v_exp_f32 v80, v80
    v_exp_f32 v81, v81
    v_exp_f32 v82, v82
    v_exp_f32 v83, v83
    v_mfma_f32_32x32x16_bf16 v[64:79], a[20:23], v[36:39], v[64:79]
    buffer_load_dwordx4 v20, s[28:31], s68 offen offset:0 lds
    v_cvt_pk_bf16_f32 v96, v80, v81
    v_cvt_pk_bf16_f32 v97, v82, v83
    v_exp_f32 v84, v84
    v_exp_f32 v85, v85
    v_exp_f32 v86, v86
    v_exp_f32 v87, v87
    v_mfma_f32_32x32x16_bf16 v[136:151], a[12:15], v[100:103], v[136:151]
    ds_write_b64 v18, v[30:31]
    v_cvt_pk_bf16_f32 v98, v84, v85
    v_cvt_pk_bf16_f32 v99, v86, v87
    v_exp_f32 v88, v88
    v_exp_f32 v89, v89
    v_exp_f32 v90, v90
    v_exp_f32 v91, v91
    v_mfma_f32_32x32x16_bf16 v[152:167], a[8:11], v[96:99], v[152:167]
    buffer_load_dwordx4 v21, s[28:31], s68 offen offset:1024 lds
    v_cvt_pk_bf16_f32 v100, v88, v89
    v_cvt_pk_bf16_f32 v101, v90, v91
    v_exp_f32 v92, v92
    v_exp_f32 v93, v93
    v_exp_f32 v94, v94
    v_exp_f32 v95, v95
    v_cvt_pk_bf16_f32 v102, v92, v93
    v_cvt_pk_bf16_f32 v103, v94, v95
    v_mfma_f32_32x32x16_bf16 v[80:95], a[16:19], v[40:43], 0
    s_waitcnt lgkmcnt(0)
    s_barrier
    v_exp_f32 v64, v64
    v_exp_f32 v65, v65
    v_exp_f32 v66, v66
    v_exp_f32 v67, v67
    v_mfma_f32_32x32x16_bf16 v[80:95], a[20:23], v[44:47], v[80:95]
    global_load_dwordx4 a[0:3], v7, s[64:65] offset:-4096 sc1
    v_cvt_pk_bf16_f32 v96, v64, v65
    v_cvt_pk_bf16_f32 v97, v66, v67
    v_exp_f32 v68, v68
    v_exp_f32 v69, v69
    v_exp_f32 v70, v70
    v_exp_f32 v71, v71
    v_mfma_f32_32x32x16_bf16 v[152:167], a[12:15], v[100:103], v[152:167]
    ds_read_b128 v[172:175], v6 offset:8192
    ds_read_b128 v[176:179], v6 offset:9216
    v_cvt_pk_bf16_f32 v98, v68, v69
    v_cvt_pk_bf16_f32 v99, v70, v71
    v_exp_f32 v72, v72
    v_exp_f32 v73, v73
    v_exp_f32 v74, v74
    v_exp_f32 v75, v75
    v_mfma_f32_32x32x16_bf16 v[104:119], a[24:27], v[96:99], v[104:119]
    global_load_dwordx4 a[4:7], v7, s[64:65] offset:-3072 sc1
    v_cvt_pk_bf16_f32 v100, v72, v73
    v_cvt_pk_bf16_f32 v101, v74, v75
    v_exp_f32 v76, v76
    v_exp_f32 v77, v77
    v_exp_f32 v78, v78
    v_exp_f32 v79, v79
    v_cvt_pk_bf16_f32 v102, v76, v77
    v_cvt_pk_bf16_f32 v103, v78, v79
    v_mfma_f32_32x32x16_bf16 v[64:79], a[16:19], v[48:51], 0
    v_exp_f32 v80, v80
    v_exp_f32 v81, v81
    v_exp_f32 v82, v82
    v_exp_f32 v83, v83
    v_mfma_f32_32x32x16_bf16 v[64:79], a[20:23], v[52:55], v[64:79]
    global_load_dwordx4 a[8:11], v7, s[64:65] offset:-2048 sc1
    v_cvt_pk_bf16_f32 v96, v80, v81
    v_cvt_pk_bf16_f32 v97, v82, v83
    v_exp_f32 v84, v84
    v_exp_f32 v85, v85
    v_exp_f32 v86, v86
    v_exp_f32 v87, v87
    v_mfma_f32_32x32x16_bf16 v[104:119], a[28:31], v[100:103], v[104:119]
    s_waitcnt lgkmcnt(0)
    v_cvt_pk_bf16_f32 v98, v84, v85
    v_cvt_pk_bf16_f32 v99, v86, v87
    v_exp_f32 v88, v88
    v_exp_f32 v89, v89
    v_exp_f32 v90, v90
    v_exp_f32 v91, v91
    v_mfma_f32_32x32x16_bf16 v[120:135], a[24:27], v[96:99], v[120:135]
    global_load_dwordx4 a[12:15], v7, s[64:65] offset:-1024 sc1
    v_cvt_pk_bf16_f32 v100, v88, v89
    v_cvt_pk_bf16_f32 v101, v90, v91
    v_exp_f32 v92, v92
    v_exp_f32 v93, v93
    v_mfma_f32_32x32x16_bf16 v[184:199], v[172:175], v[232:235], 0
    v_exp_f32 v94, v94
    v_exp_f32 v95, v95
    v_cvt_pk_bf16_f32 v102, v92, v93
    v_cvt_pk_bf16_f32 v103, v94, v95
    v_mfma_f32_32x32x16_bf16 v[80:95], a[16:19], v[56:59], 0
    s_barrier
    v_exp_f32 v64, v64
    v_exp_f32 v65, v65
    v_exp_f32 v66, v66
    v_exp_f32 v67, v67
    v_mfma_f32_32x32x16_bf16 v[80:95], a[20:23], v[60:63], v[80:95]
    buffer_load_dwordx4 v22, s[28:31], s68 offen offset:2048 lds
    v_cvt_pk_bf16_f32 v96, v64, v65
    v_cvt_pk_bf16_f32 v97, v66, v67
    v_exp_f32 v68, v68
    v_exp_f32 v69, v69
    v_exp_f32 v70, v70
    v_exp_f32 v71, v71
    v_mfma_f32_32x32x16_bf16 v[120:135], a[28:31], v[100:103], v[120:135]
    v_cvt_pk_bf16_f32 v98, v68, v69
    v_cvt_pk_bf16_f32 v99, v70, v71
    v_exp_f32 v72, v72
    v_exp_f32 v73, v73
    v_exp_f32 v74, v74
    v_exp_f32 v75, v75
    v_mfma_f32_32x32x16_bf16 v[136:151], a[24:27], v[96:99], v[136:151]
    buffer_load_dwordx4 v23, s[28:31], s68 offen offset:3072 lds
    v_cvt_pk_bf16_f32 v100, v72, v73
    v_cvt_pk_bf16_f32 v101, v74, v75
    v_exp_f32 v76, v76
    v_exp_f32 v77, v77
    v_mfma_f32_32x32x16_bf16 v[184:199], v[176:179], v[236:239], v[184:199]
    v_exp_f32 v78, v78
    v_exp_f32 v79, v79
    v_cvt_pk_bf16_f32 v102, v76, v77
    v_cvt_pk_bf16_f32 v103, v78, v79
    v_mfma_f32_32x32x16_bf16 v[64:79], a[32:35], v[32:35], 0
    s_add_u32 m0, s60, 53248
    v_exp_f32 v80, v80
    v_exp_f32 v81, v81
    v_exp_f32 v82, v82
    v_exp_f32 v83, v83
    v_mfma_f32_32x32x16_bf16 v[64:79], a[36:39], v[36:39], v[64:79]
    buffer_load_dwordx4 v20, s[28:31], s69 offen offset:0 lds
    v_cvt_pk_bf16_f32 v96, v80, v81
    v_cvt_pk_bf16_f32 v97, v82, v83
    v_exp_f32 v84, v84
    v_exp_f32 v85, v85
    v_exp_f32 v86, v86
    v_exp_f32 v87, v87
    v_mfma_f32_32x32x16_bf16 v[136:151], a[28:31], v[100:103], v[136:151]
    v_mov_b32 v3, v196
    v_sub_f32 v5, 1.0, v10
    v_cvt_pk_bf16_f32 v98, v84, v85
    v_cvt_pk_bf16_f32 v99, v86, v87
    v_exp_f32 v88, v88
    v_exp_f32 v89, v89
    v_exp_f32 v90, v90
    v_exp_f32 v91, v91
    v_mfma_f32_32x32x16_bf16 v[152:167], a[24:27], v[96:99], v[152:167]
    buffer_load_dwordx4 v21, s[28:31], s69 offen offset:1024 lds
    v_permlane32_swap_b32 v196, v3
    v_add_f32 v3, 0x358637bd, v3
    v_rcp_f32 v3, v3
    v_cvt_pk_bf16_f32 v100, v88, v89
    v_cvt_pk_bf16_f32 v101, v90, v91
    v_exp_f32 v92, v92
    v_exp_f32 v93, v93
    v_exp_f32 v94, v94
    v_exp_f32 v95, v95
    v_cvt_pk_bf16_f32 v102, v92, v93
    v_cvt_pk_bf16_f32 v103, v94, v95
    v_mfma_f32_32x32x16_bf16 v[80:95], a[32:35], v[40:43], 0
    v_mul_f32 v3, v3, v5
    v_mul_f32 v184, v3, v184
    v_mul_f32 v185, v3, v185
    v_mul_f32 v186, v3, v186
    v_mul_f32 v187, v3, v187
    v_exp_f32 v64, v64
    v_exp_f32 v65, v65
    v_exp_f32 v66, v66
    v_exp_f32 v67, v67
    v_mfma_f32_32x32x16_bf16 v[80:95], a[36:39], v[44:47], v[80:95]
    global_load_dwordx4 a[16:19], v7, s[64:65] offset:0 sc1
    v_mul_f32 v188, v3, v188
    v_mul_f32 v189, v3, v189
    v_mul_f32 v190, v3, v190
    v_mul_f32 v191, v3, v191
    v_cvt_pk_bf16_f32 v96, v64, v65
    v_cvt_pk_bf16_f32 v97, v66, v67
    v_exp_f32 v68, v68
    v_exp_f32 v69, v69
    v_exp_f32 v70, v70
    v_exp_f32 v71, v71
    v_mfma_f32_32x32x16_bf16 v[152:167], a[28:31], v[100:103], v[152:167]
    v_mul_f32 v192, v3, v192
    v_mul_f32 v193, v3, v193
    v_mul_f32 v194, v3, v194
    v_mul_f32 v195, v3, v195
    v_cvt_pk_bf16_f32 v98, v68, v69
    v_cvt_pk_bf16_f32 v99, v70, v71
    v_exp_f32 v72, v72
    v_exp_f32 v73, v73
    v_exp_f32 v74, v74
    v_exp_f32 v75, v75
    v_mfma_f32_32x32x16_bf16 v[104:119], a[40:43], v[96:99], v[104:119]
    global_load_dwordx4 a[20:23], v7, s[64:65] offset:1024 sc1
    v_mul_f32 v196, v3, v196
    v_mul_f32 v197, v3, v197
    v_mul_f32 v198, v3, v198
    v_mul_f32 v199, v3, v199
    v_cvt_pk_bf16_f32 v100, v72, v73
    v_cvt_pk_bf16_f32 v101, v74, v75
    v_exp_f32 v76, v76
    v_exp_f32 v77, v77
    v_exp_f32 v78, v78
    v_exp_f32 v79, v79
    v_cvt_pk_bf16_f32 v102, v76, v77
    v_cvt_pk_bf16_f32 v103, v78, v79
    v_mfma_f32_32x32x16_bf16 v[64:79], a[32:35], v[48:51], 0
    v_cvt_pk_bf16_f32 v240, v184, v185
    v_cvt_pk_bf16_f32 v241, v186, v187
    v_cvt_pk_bf16_f32 v242, v188, v189
    v_cvt_pk_bf16_f32 v243, v190, v191
    v_cvt_pk_bf16_f32 v244, v192, v193
    v_cvt_pk_bf16_f32 v245, v194, v195
    s_mov_b64 exec, 0xffffffff
    v_cvt_pk_bf16_f32 v246, v196, v197
    v_cvt_pk_bf16_f32 v247, v198, v199
    s_mov_b64 exec, -1
    v_exp_f32 v80, v80
    v_exp_f32 v81, v81
    v_exp_f32 v82, v82
    v_exp_f32 v83, v83
    v_mfma_f32_32x32x16_bf16 v[64:79], a[36:39], v[52:55], v[64:79]
    global_load_dwordx4 a[24:27], v7, s[64:65] offset:2048 sc1
    v_cvt_pk_bf16_f32 v96, v80, v81
    v_cvt_pk_bf16_f32 v97, v82, v83
    v_exp_f32 v84, v84
    v_exp_f32 v85, v85
    v_exp_f32 v86, v86
    v_exp_f32 v87, v87
    v_mfma_f32_32x32x16_bf16 v[104:119], a[44:47], v[100:103], v[104:119]
    v_cvt_pk_bf16_f32 v98, v84, v85
    v_cvt_pk_bf16_f32 v99, v86, v87
    v_exp_f32 v88, v88
    v_exp_f32 v89, v89
    v_exp_f32 v90, v90
    v_exp_f32 v91, v91
    v_mfma_f32_32x32x16_bf16 v[120:135], a[40:43], v[96:99], v[120:135]
    global_load_dwordx4 a[28:31], v7, s[64:65] offset:3072 sc1
    v_add_u32 v7, 0x2000, v7
    v_cvt_pk_bf16_f32 v100, v88, v89
    v_cvt_pk_bf16_f32 v101, v90, v91
    v_exp_f32 v92, v92
    v_exp_f32 v93, v93
    v_exp_f32 v94, v94
    v_exp_f32 v95, v95
    v_cvt_pk_bf16_f32 v102, v92, v93
    v_cvt_pk_bf16_f32 v103, v94, v95
    v_mfma_f32_32x32x16_bf16 v[80:95], a[32:35], v[56:59], 0
    v_exp_f32 v64, v64
    v_exp_f32 v65, v65
    v_exp_f32 v66, v66
    v_exp_f32 v67, v67
    v_mfma_f32_32x32x16_bf16 v[80:95], a[36:39], v[60:63], v[80:95]
    buffer_store_dwordx4 v[240:243], v6, s[16:19], s62 offen offset:0 sc1
    v_cvt_pk_bf16_f32 v96, v64, v65
    v_cvt_pk_bf16_f32 v97, v66, v67
    v_exp_f32 v68, v68
    v_exp_f32 v69, v69
    v_exp_f32 v70, v70
    v_exp_f32 v71, v71
    v_mfma_f32_32x32x16_bf16 v[120:135], a[44:47], v[100:103], v[120:135]
    s_waitcnt vmcnt(19)
    v_cvt_pk_bf16_f32 v98, v68, v69
    v_cvt_pk_bf16_f32 v99, v70, v71
    v_exp_f32 v72, v72
    v_exp_f32 v73, v73
    v_exp_f32 v74, v74
    v_exp_f32 v75, v75
    v_mfma_f32_32x32x16_bf16 v[136:151], a[40:43], v[96:99], v[136:151]
    buffer_store_dwordx4 v[244:247], v6, s[16:19], s62 offen offset:1024 sc1
    v_cvt_pk_bf16_f32 v100, v72, v73
    v_cvt_pk_bf16_f32 v101, v74, v75
    v_exp_f32 v76, v76
    v_exp_f32 v77, v77
    v_exp_f32 v78, v78
    v_exp_f32 v79, v79
    v_cvt_pk_bf16_f32 v102, v76, v77
    v_cvt_pk_bf16_f32 v103, v78, v79
    v_mfma_f32_32x32x16_bf16 v[64:79], a[48:51], v[32:35], 0
    v_exp_f32 v80, v80
    v_exp_f32 v81, v81
    v_exp_f32 v82, v82
    v_exp_f32 v83, v83
    v_mfma_f32_32x32x16_bf16 v[64:79], a[52:55], v[36:39], v[64:79]
    buffer_load_dwordx4 v22, s[28:31], s69 offen offset:2048 lds
    v_cvt_pk_bf16_f32 v96, v80, v81
    v_cvt_pk_bf16_f32 v97, v82, v83
    v_exp_f32 v84, v84
    v_exp_f32 v85, v85
    v_exp_f32 v86, v86
    v_exp_f32 v87, v87
    v_mfma_f32_32x32x16_bf16 v[136:151], a[44:47], v[100:103], v[136:151]
    v_cvt_pk_bf16_f32 v98, v84, v85
    v_cvt_pk_bf16_f32 v99, v86, v87
    v_exp_f32 v88, v88
    v_exp_f32 v89, v89
    v_exp_f32 v90, v90
    v_exp_f32 v91, v91
    v_mfma_f32_32x32x16_bf16 v[152:167], a[40:43], v[96:99], v[152:167]
    buffer_load_dwordx4 v23, s[28:31], s69 offen offset:3072 lds
    v_cvt_pk_bf16_f32 v100, v88, v89
    v_cvt_pk_bf16_f32 v101, v90, v91
    v_exp_f32 v92, v92
    v_exp_f32 v93, v93
    v_exp_f32 v94, v94
    v_exp_f32 v95, v95
    v_cvt_pk_bf16_f32 v102, v92, v93
    v_cvt_pk_bf16_f32 v103, v94, v95
    v_mfma_f32_32x32x16_bf16 v[80:95], a[48:51], v[40:43], 0
    s_add_u32 m0, s60, 57344
    v_exp_f32 v64, v64
    v_exp_f32 v65, v65
    v_exp_f32 v66, v66
    v_exp_f32 v67, v67
    v_mfma_f32_32x32x16_bf16 v[80:95], a[52:55], v[44:47], v[80:95]
    global_load_dwordx4 a[32:35], v7, s[64:65] offset:-4096 sc1
    v_cvt_pk_bf16_f32 v96, v64, v65
    v_cvt_pk_bf16_f32 v97, v66, v67
    v_exp_f32 v68, v68
    v_exp_f32 v69, v69
    v_exp_f32 v70, v70
    v_exp_f32 v71, v71
    v_mfma_f32_32x32x16_bf16 v[152:167], a[44:47], v[100:103], v[152:167]
    s_waitcnt vmcnt(21)
    v_cvt_pk_bf16_f32 v98, v68, v69
    v_cvt_pk_bf16_f32 v99, v70, v71
    v_exp_f32 v72, v72
    v_exp_f32 v73, v73
    v_exp_f32 v74, v74
    v_exp_f32 v75, v75
    v_mfma_f32_32x32x16_bf16 v[104:119], a[56:59], v[96:99], v[104:119]
    global_load_dwordx4 a[36:39], v7, s[64:65] offset:-3072 sc1
    v_cvt_pk_bf16_f32 v100, v72, v73
    v_cvt_pk_bf16_f32 v101, v74, v75
    v_exp_f32 v76, v76
    v_exp_f32 v77, v77
    v_exp_f32 v78, v78
    v_exp_f32 v79, v79
    v_cvt_pk_bf16_f32 v102, v76, v77
    v_cvt_pk_bf16_f32 v103, v78, v79
    v_mfma_f32_32x32x16_bf16 v[64:79], a[48:51], v[48:51], 0
    v_exp_f32 v80, v80
    v_exp_f32 v81, v81
    v_exp_f32 v82, v82
    v_exp_f32 v83, v83
    v_mfma_f32_32x32x16_bf16 v[64:79], a[52:55], v[52:55], v[64:79]
    global_load_dwordx4 a[40:43], v7, s[64:65] offset:-2048 sc1
    v_cvt_pk_bf16_f32 v96, v80, v81
    v_cvt_pk_bf16_f32 v97, v82, v83
    v_exp_f32 v84, v84
    v_exp_f32 v85, v85
    v_exp_f32 v86, v86
    v_exp_f32 v87, v87
    v_mfma_f32_32x32x16_bf16 v[104:119], a[60:63], v[100:103], v[104:119]
    v_cvt_pk_bf16_f32 v98, v84, v85
    v_cvt_pk_bf16_f32 v99, v86, v87
    v_exp_f32 v88, v88
    v_exp_f32 v89, v89
    v_exp_f32 v90, v90
    v_exp_f32 v91, v91
    v_mfma_f32_32x32x16_bf16 v[120:135], a[56:59], v[96:99], v[120:135]
    global_load_dwordx4 a[44:47], v7, s[64:65] offset:-1024 sc1
    v_cvt_pk_bf16_f32 v100, v88, v89
    v_cvt_pk_bf16_f32 v101, v90, v91
    v_exp_f32 v92, v92
    v_exp_f32 v93, v93
    v_exp_f32 v94, v94
    v_exp_f32 v95, v95
    v_cvt_pk_bf16_f32 v102, v92, v93
    v_cvt_pk_bf16_f32 v103, v94, v95
    v_mfma_f32_32x32x16_bf16 v[80:95], a[48:51], v[56:59], 0
    v_exp_f32 v64, v64
    v_exp_f32 v65, v65
    v_exp_f32 v66, v66
    v_exp_f32 v67, v67
    v_mfma_f32_32x32x16_bf16 v[80:95], a[52:55], v[60:63], v[80:95]
    buffer_load_dwordx4 v20, s[28:31], s70 offen offset:0 lds
    v_cvt_pk_bf16_f32 v96, v64, v65
    v_cvt_pk_bf16_f32 v97, v66, v67
    v_exp_f32 v68, v68
    v_exp_f32 v69, v69
    v_exp_f32 v70, v70
    v_exp_f32 v71, v71
    v_mfma_f32_32x32x16_bf16 v[120:135], a[60:63], v[100:103], v[120:135]
    s_waitcnt vmcnt(19)
    v_cvt_pk_bf16_f32 v98, v68, v69
    v_cvt_pk_bf16_f32 v99, v70, v71
    v_exp_f32 v72, v72
    v_exp_f32 v73, v73
    v_exp_f32 v74, v74
    v_exp_f32 v75, v75
    v_mfma_f32_32x32x16_bf16 v[136:151], a[56:59], v[96:99], v[136:151]
    buffer_load_dwordx4 v21, s[28:31], s70 offen offset:1024 lds
    v_cvt_pk_bf16_f32 v100, v72, v73
    v_cvt_pk_bf16_f32 v101, v74, v75
    v_exp_f32 v76, v76
    v_exp_f32 v77, v77
    v_exp_f32 v78, v78
    v_exp_f32 v79, v79
    v_cvt_pk_bf16_f32 v102, v76, v77
    v_cvt_pk_bf16_f32 v103, v78, v79
    v_mfma_f32_32x32x16_bf16 v[64:79], a[0:3], v[32:35], 0
    v_exp_f32 v80, v80
    v_exp_f32 v81, v81
    v_exp_f32 v82, v82
    v_exp_f32 v83, v83
    v_mfma_f32_32x32x16_bf16 v[64:79], a[4:7], v[36:39], v[64:79]
    buffer_load_dwordx4 v22, s[28:31], s70 offen offset:2048 lds
    v_cvt_pk_bf16_f32 v96, v80, v81
    v_cvt_pk_bf16_f32 v97, v82, v83
    v_exp_f32 v84, v84
    v_exp_f32 v85, v85
    v_exp_f32 v86, v86
    v_exp_f32 v87, v87
    v_mfma_f32_32x32x16_bf16 v[136:151], a[60:63], v[100:103], v[136:151]
    v_cvt_pk_bf16_f32 v98, v84, v85
    v_cvt_pk_bf16_f32 v99, v86, v87
    v_exp_f32 v88, v88
    v_exp_f32 v89, v89
    v_exp_f32 v90, v90
    v_exp_f32 v91, v91
    v_mfma_f32_32x32x16_bf16 v[152:167], a[56:59], v[96:99], v[152:167]
    buffer_load_dwordx4 v23, s[28:31], s70 offen offset:3072 lds
    v_cvt_pk_bf16_f32 v100, v88, v89
    v_cvt_pk_bf16_f32 v101, v90, v91
    v_exp_f32 v92, v92
    v_exp_f32 v93, v93
    v_exp_f32 v94, v94
    v_exp_f32 v95, v95
    v_cvt_pk_bf16_f32 v102, v92, v93
    v_cvt_pk_bf16_f32 v103, v94, v95
    v_mfma_f32_32x32x16_bf16 v[80:95], a[0:3], v[40:43], 0
    s_add_u32 m0, s60, 61440
    v_exp_f32 v64, v64
    v_exp_f32 v65, v65
    v_exp_f32 v66, v66
    v_exp_f32 v67, v67
    v_mfma_f32_32x32x16_bf16 v[80:95], a[4:7], v[44:47], v[80:95]
    global_load_dwordx4 a[48:51], v7, s[64:65] offset:0 sc1
    v_cvt_pk_bf16_f32 v96, v64, v65
    v_cvt_pk_bf16_f32 v97, v66, v67
    v_exp_f32 v68, v68
    v_exp_f32 v69, v69
    v_exp_f32 v70, v70
    v_exp_f32 v71, v71
    v_mfma_f32_32x32x16_bf16 v[152:167], a[60:63], v[100:103], v[152:167]
    s_waitcnt vmcnt(21)
    v_cvt_pk_bf16_f32 v98, v68, v69
    v_cvt_pk_bf16_f32 v99, v70, v71
    v_exp_f32 v72, v72
    v_exp_f32 v73, v73
    v_exp_f32 v74, v74
    v_exp_f32 v75, v75
    v_mfma_f32_32x32x16_bf16 v[104:119], a[8:11], v[96:99], v[104:119]
    global_load_dwordx4 a[52:55], v7, s[64:65] offset:1024 sc1
    v_cvt_pk_bf16_f32 v100, v72, v73
    v_cvt_pk_bf16_f32 v101, v74, v75
    v_exp_f32 v76, v76
    v_exp_f32 v77, v77
    v_exp_f32 v78, v78
    v_exp_f32 v79, v79
    v_cvt_pk_bf16_f32 v102, v76, v77
    v_cvt_pk_bf16_f32 v103, v78, v79
    v_mfma_f32_32x32x16_bf16 v[64:79], a[0:3], v[48:51], 0
    v_exp_f32 v80, v80
    v_exp_f32 v81, v81
    v_exp_f32 v82, v82
    v_exp_f32 v83, v83
    v_mfma_f32_32x32x16_bf16 v[64:79], a[4:7], v[52:55], v[64:79]
    global_load_dwordx4 a[56:59], v7, s[64:65] offset:2048 sc1
    v_cvt_pk_bf16_f32 v96, v80, v81
    v_cvt_pk_bf16_f32 v97, v82, v83
    v_exp_f32 v84, v84
    v_exp_f32 v85, v85
    v_exp_f32 v86, v86
    v_exp_f32 v87, v87
    v_mfma_f32_32x32x16_bf16 v[104:119], a[12:15], v[100:103], v[104:119]
    v_cvt_pk_bf16_f32 v98, v84, v85
    v_cvt_pk_bf16_f32 v99, v86, v87
    v_exp_f32 v88, v88
    v_exp_f32 v89, v89
    v_exp_f32 v90, v90
    v_exp_f32 v91, v91
    v_mfma_f32_32x32x16_bf16 v[120:135], a[8:11], v[96:99], v[120:135]
    global_load_dwordx4 a[60:63], v7, s[64:65] offset:3072 sc1
    v_add_u32 v7, 0x2000, v7
    v_cvt_pk_bf16_f32 v100, v88, v89
    v_cvt_pk_bf16_f32 v101, v90, v91
    v_exp_f32 v92, v92
    v_exp_f32 v93, v93
    v_exp_f32 v94, v94
    v_exp_f32 v95, v95
    v_cvt_pk_bf16_f32 v102, v92, v93
    v_cvt_pk_bf16_f32 v103, v94, v95
    v_mfma_f32_32x32x16_bf16 v[80:95], a[0:3], v[56:59], 0
L_f_pad11:
    s_cbranch_execz L_f_tdone
    v_exp_f32 v64, v64
    v_exp_f32 v65, v65
    v_exp_f32 v66, v66
    v_exp_f32 v67, v67
    v_mfma_f32_32x32x16_bf16 v[80:95], a[4:7], v[60:63], v[80:95]
    buffer_load_dwordx4 v20, s[28:31], s71 offen offset:0 lds
    v_cvt_pk_bf16_f32 v96, v64, v65
    v_cvt_pk_bf16_f32 v97, v66, v67
    v_exp_f32 v68, v68
    v_exp_f32 v69, v69
    v_exp_f32 v70, v70
    v_exp_f32 v71, v71
    v_mfma_f32_32x32x16_bf16 v[120:135], a[12:15], v[100:103], v[120:135]
    s_waitcnt vmcnt(19)
    s_waitcnt vmcnt(15)
    v_lshlrev_b32 v2, 2, v1
    v_mov_b32 v3, s67
    s_mov_b64 exec, 0xffffffff
    buffer_store_dword v3, v2, s[16:19], s63 offen sc1
    s_mov_b64 exec, -1
    v_cvt_pk_bf16_f32 v98, v68, v69
    v_cvt_pk_bf16_f32 v99, v70, v71
    v_exp_f32 v72, v72
    v_exp_f32 v73, v73
    v_exp_f32 v74, v74
    v_exp_f32 v75, v75
    v_mfma_f32_32x32x16_bf16 v[136:151], a[8:11], v[96:99], v[136:151]
    buffer_load_dwordx4 v21, s[28:31], s71 offen offset:1024 lds
    v_cvt_pk_bf16_f32 v100, v72, v73
    v_cvt_pk_bf16_f32 v101, v74, v75
    v_exp_f32 v76, v76
    v_exp_f32 v77, v77
    v_exp_f32 v78, v78
    v_exp_f32 v79, v79
    v_cvt_pk_bf16_f32 v102, v76, v77
    v_cvt_pk_bf16_f32 v103, v78, v79
    v_mfma_f32_32x32x16_bf16 v[64:79], a[16:19], v[32:35], 0
    s_add_u32 m0, s60, 106496
    v_exp_f32 v80, v80
    v_exp_f32 v81, v81
    v_exp_f32 v82, v82
    v_exp_f32 v83, v83
    v_mfma_f32_32x32x16_bf16 v[64:79], a[20:23], v[36:39], v[64:79]
    buffer_load_dwordx4 v20, s[24:27], s68 offen offset:0 lds
    v_cvt_pk_bf16_f32 v96, v80, v81
    v_cvt_pk_bf16_f32 v97, v82, v83
    v_exp_f32 v84, v84
    v_exp_f32 v85, v85
    v_exp_f32 v86, v86
    v_exp_f32 v87, v87
    v_mfma_f32_32x32x16_bf16 v[136:151], a[12:15], v[100:103], v[136:151]
    v_cvt_pk_bf16_f32 v98, v84, v85
    v_cvt_pk_bf16_f32 v99, v86, v87
    v_exp_f32 v88, v88
    v_exp_f32 v89, v89
    v_exp_f32 v90, v90
    v_exp_f32 v91, v91
    v_mfma_f32_32x32x16_bf16 v[152:167], a[8:11], v[96:99], v[152:167]
    buffer_load_dwordx4 v21, s[24:27], s68 offen offset:1024 lds
    v_cvt_pk_bf16_f32 v100, v88, v89
    v_cvt_pk_bf16_f32 v101, v90, v91
    v_exp_f32 v92, v92
    v_exp_f32 v93, v93
    v_exp_f32 v94, v94
    v_exp_f32 v95, v95
    v_cvt_pk_bf16_f32 v102, v92, v93
    v_cvt_pk_bf16_f32 v103, v94, v95
    v_mfma_f32_32x32x16_bf16 v[80:95], a[16:19], v[40:43], 0
    v_exp_f32 v64, v64
    v_exp_f32 v65, v65
    v_exp_f32 v66, v66
    v_exp_f32 v67, v67
    v_mfma_f32_32x32x16_bf16 v[80:95], a[20:23], v[44:47], v[80:95]
    global_load_dwordx4 a[0:3], v7, s[64:65] offset:-4096 sc1
    v_cvt_pk_bf16_f32 v96, v64, v65
    v_cvt_pk_bf16_f32 v97, v66, v67
    v_exp_f32 v68, v68
    v_exp_f32 v69, v69
    v_exp_f32 v70, v70
    v_exp_f32 v71, v71
    v_mfma_f32_32x32x16_bf16 v[152:167], a[12:15], v[100:103], v[152:167]
    v_cvt_pk_bf16_f32 v98, v68, v69
    v_cvt_pk_bf16_f32 v99, v70, v71
    v_exp_f32 v72, v72
    v_exp_f32 v73, v73
    v_exp_f32 v74, v74
    v_exp_f32 v75, v75
    v_mfma_f32_32x32x16_bf16 v[104:119], a[24:27], v[96:99], v[104:119]
    global_load_dwordx4 a[4:7], v7, s[64:65] offset:-3072 sc1
    v_cvt_pk_bf16_f32 v100, v72, v73
    v_cvt_pk_bf16_f32 v101, v74, v75
    v_exp_f32 v76, v76
    v_exp_f32 v77, v77
    v_exp_f32 v78, v78
    v_exp_f32 v79, v79
    v_cvt_pk_bf16_f32 v102, v76, v77
    v_cvt_pk_bf16_f32 v103, v78, v79
    v_mfma_f32_32x32x16_bf16 v[64:79], a[16:19], v[48:51], 0
    v_exp_f32 v80, v80
    v_exp_f32 v81, v81
    v_exp_f32 v82, v82
    v_exp_f32 v83, v83
    v_mfma_f32_32x32x16_bf16 v[64:79], a[20:23], v[52:55], v[64:79]
    global_load_dwordx4 a[8:11], v7, s[64:65] offset:-2048 sc1
    v_cvt_pk_bf16_f32 v96, v80, v81
    v_cvt_pk_bf16_f32 v97, v82, v83
    v_exp_f32 v84, v84
    v_exp_f32 v85, v85
    v_exp_f32 v86, v86
    v_exp_f32 v87, v87
    v_mfma_f32_32x32x16_bf16 v[104:119], a[28:31], v[100:103], v[104:119]
    v_cvt_pk_bf16_f32 v98, v84, v85
    v_cvt_pk_bf16_f32 v99, v86, v87
    v_exp_f32 v88, v88
    v_exp_f32 v89, v89
    v_exp_f32 v90, v90
    v_exp_f32 v91, v91
    v_mfma_f32_32x32x16_bf16 v[120:135], a[24:27], v[96:99], v[120:135]
    global_load_dwordx4 a[12:15], v7, s[64:65] offset:-1024 sc1
    v_cvt_pk_bf16_f32 v100, v88, v89
    v_cvt_pk_bf16_f32 v101, v90, v91
    v_exp_f32 v92, v92
    v_exp_f32 v93, v93
    v_exp_f32 v94, v94
    v_exp_f32 v95, v95
    v_cvt_pk_bf16_f32 v102, v92, v93
    v_cvt_pk_bf16_f32 v103, v94, v95
    v_mfma_f32_32x32x16_bf16 v[80:95], a[16:19], v[56:59], 0
    v_exp_f32 v64, v64
    v_exp_f32 v65, v65
    v_exp_f32 v66, v66
    v_exp_f32 v67, v67
    v_mfma_f32_32x32x16_bf16 v[80:95], a[20:23], v[60:63], v[80:95]
    buffer_load_dwordx4 v22, s[24:27], s68 offen offset:2048 lds
    v_cvt_pk_bf16_f32 v96, v64, v65
    v_cvt_pk_bf16_f32 v97, v66, v67
    v_exp_f32 v68, v68
    v_exp_f32 v69, v69
    v_exp_f32 v70, v70
    v_exp_f32 v71, v71
    v_mfma_f32_32x32x16_bf16 v[120:135], a[28:31], v[100:103], v[120:135]
    s_waitcnt vmcnt(20)
    v_cvt_pk_bf16_f32 v98, v68, v69
    v_cvt_pk_bf16_f32 v99, v70, v71
    v_exp_f32 v72, v72
    v_exp_f32 v73, v73
    v_exp_f32 v74, v74
    v_exp_f32 v75, v75
    v_mfma_f32_32x32x16_bf16 v[136:151], a[24:27], v[96:99], v[136:151]
    buffer_load_dwordx4 v23, s[24:27], s68 offen offset:3072 lds
    v_cvt_pk_bf16_f32 v100, v72, v73
    v_cvt_pk_bf16_f32 v101, v74, v75
    v_exp_f32 v76, v76
    v_exp_f32 v77, v77
    v_exp_f32 v78, v78
    v_exp_f32 v79, v79
    v_cvt_pk_bf16_f32 v102, v76, v77
    v_cvt_pk_bf16_f32 v103, v78, v79
    v_mfma_f32_32x32x16_bf16 v[64:79], a[32:35], v[32:35], 0
    s_add_u32 m0, s60, 110592
    v_exp_f32 v80, v80
    v_exp_f32 v81, v81
    v_exp_f32 v82, v82
    v_exp_f32 v83, v83
    v_mfma_f32_32x32x16_bf16 v[64:79], a[36:39], v[36:39], v[64:79]
    buffer_load_dwordx4 v20, s[24:27], s69 offen offset:0 lds
    v_cvt_pk_bf16_f32 v96, v80, v81
    v_cvt_pk_bf16_f32 v97, v82, v83
    v_exp_f32 v84, v84
    v_exp_f32 v85, v85
    v_exp_f32 v86, v86
    v_exp_f32 v87, v87
    v_mfma_f32_32x32x16_bf16 v[136:151], a[28:31], v[100:103], v[136:151]
    v_cvt_pk_bf16_f32 v98, v84, v85
    v_cvt_pk_bf16_f32 v99, v86, v87
    v_exp_f32 v88, v88
    v_exp_f32 v89, v89
    v_exp_f32 v90, v90
    v_exp_f32 v91, v91
    v_mfma_f32_32x32x16_bf16 v[152:167], a[24:27], v[96:99], v[152:167]
    buffer_load_dwordx4 v21, s[24:27], s69 offen offset:1024 lds
    v_cvt_pk_bf16_f32 v100, v88, v89
    v_cvt_pk_bf16_f32 v101, v90, v91
    v_exp_f32 v92, v92
    v_exp_f32 v93, v93
    v_exp_f32 v94, v94
    v_exp_f32 v95, v95
    v_cvt_pk_bf16_f32 v102, v92, v93
    v_cvt_pk_bf16_f32 v103, v94, v95
    v_mfma_f32_32x32x16_bf16 v[80:95], a[32:35], v[40:43], 0
    v_exp_f32 v64, v64
    v_exp_f32 v65, v65
    v_exp_f32 v66, v66
    v_exp_f32 v67, v67
    v_mfma_f32_32x32x16_bf16 v[80:95], a[36:39], v[44:47], v[80:95]
    global_load_dwordx4 a[16:19], v7, s[64:65] offset:0 sc1
    v_cvt_pk_bf16_f32 v96, v64, v65
    v_cvt_pk_bf16_f32 v97, v66, v67
    v_exp_f32 v68, v68
    v_exp_f32 v69, v69
    v_exp_f32 v70, v70
    v_exp_f32 v71, v71
    v_mfma_f32_32x32x16_bf16 v[152:167], a[28:31], v[100:103], v[152:167]
    s_waitcnt vmcnt(22)
    v_cvt_pk_bf16_f32 v98, v68, v69
    v_cvt_pk_bf16_f32 v99, v70, v71
    v_exp_f32 v72, v72
    v_exp_f32 v73, v73
    v_exp_f32 v74, v74
    v_exp_f32 v75, v75
    v_mfma_f32_32x32x16_bf16 v[104:119], a[40:43], v[96:99], v[104:119]
    global_load_dwordx4 a[20:23], v7, s[64:65] offset:1024 sc1
    v_cvt_pk_bf16_f32 v100, v72, v73
    v_cvt_pk_bf16_f32 v101, v74, v75
    v_exp_f32 v76, v76
    v_exp_f32 v77, v77
    v_exp_f32 v78, v78
    v_exp_f32 v79, v79
    v_cvt_pk_bf16_f32 v102, v76, v77
    v_cvt_pk_bf16_f32 v103, v78, v79
    v_mfma_f32_32x32x16_bf16 v[64:79], a[32:35], v[48:51], 0
    v_exp_f32 v80, v80
    v_exp_f32 v81, v81
    v_exp_f32 v82, v82
    v_exp_f32 v83, v83
    v_mfma_f32_32x32x16_bf16 v[64:79], a[36:39], v[52:55], v[64:79]
    global_load_dwordx4 a[24:27], v7, s[64:65] offset:2048 sc1
    v_cvt_pk_bf16_f32 v96, v80, v81
    v_cvt_pk_bf16_f32 v97, v82, v83
    v_exp_f32 v84, v84
    v_exp_f32 v85, v85
    v_exp_f32 v86, v86
    v_exp_f32 v87, v87
    v_mfma_f32_32x32x16_bf16 v[104:119], a[44:47], v[100:103], v[104:119]
    v_cvt_pk_bf16_f32 v98, v84, v85
    v_cvt_pk_bf16_f32 v99, v86, v87
    v_exp_f32 v88, v88
    v_exp_f32 v89, v89
    v_exp_f32 v90, v90
    v_exp_f32 v91, v91
    v_mfma_f32_32x32x16_bf16 v[120:135], a[40:43], v[96:99], v[120:135]
    global_load_dwordx4 a[28:31], v7, s[64:65] offset:3072 sc1
    v_add_u32 v7, 0x2000, v7
    v_cvt_pk_bf16_f32 v100, v88, v89
    v_cvt_pk_bf16_f32 v101, v90, v91
    v_exp_f32 v92, v92
    v_exp_f32 v93, v93
    v_exp_f32 v94, v94
    v_exp_f32 v95, v95
    v_cvt_pk_bf16_f32 v102, v92, v93
    v_cvt_pk_bf16_f32 v103, v94, v95
    v_mfma_f32_32x32x16_bf16 v[80:95], a[32:35], v[56:59], 0
    v_exp_f32 v64, v64
    v_exp_f32 v65, v65
    v_exp_f32 v66, v66
    v_exp_f32 v67, v67
    v_mfma_f32_32x32x16_bf16 v[80:95], a[36:39], v[60:63], v[80:95]
    buffer_load_dwordx4 v22, s[24:27], s69 offen offset:2048 lds
    v_cvt_pk_bf16_f32 v96, v64, v65
    v_cvt_pk_bf16_f32 v97, v66, v67
    v_exp_f32 v68, v68
    v_exp_f32 v69, v69
    v_exp_f32 v70, v70
    v_exp_f32 v71, v71
    v_mfma_f32_32x32x16_bf16 v[120:135], a[44:47], v[100:103], v[120:135]
    s_waitcnt vmcnt(20)
    v_cvt_pk_bf16_f32 v98, v68, v69
    v_cvt_pk_bf16_f32 v99, v70, v71
    v_exp_f32 v72, v72
    v_exp_f32 v73, v73
    v_exp_f32 v74, v74
    v_exp_f32 v75, v75
    v_mfma_f32_32x32x16_bf16 v[136:151], a[40:43], v[96:99], v[136:151]
    buffer_load_dwordx4 v23, s[24:27], s69 offen offset:3072 lds
    v_cvt_pk_bf16_f32 v100, v72, v73
    v_cvt_pk_bf16_f32 v101, v74, v75
    v_exp_f32 v76, v76
    v_exp_f32 v77, v77
    v_exp_f32 v78, v78
    v_exp_f32 v79, v79
    v_cvt_pk_bf16_f32 v102, v76, v77
    v_cvt_pk_bf16_f32 v103, v78, v79
    v_mfma_f32_32x32x16_bf16 v[64:79], a[48:51], v[32:35], 0
    s_add_u32 m0, s60, 114688
    v_exp_f32 v80, v80
    v_exp_f32 v81, v81
    v_exp_f32 v82, v82
    v_exp_f32 v83, v83
    v_mfma_f32_32x32x16_bf16 v[64:79], a[52:55], v[36:39], v[64:79]
    buffer_load_dwordx4 v20, s[24:27], s70 offen offset:0 lds
    v_cvt_pk_bf16_f32 v96, v80, v81
    v_cvt_pk_bf16_f32 v97, v82, v83
    v_exp_f32 v84, v84
    v_exp_f32 v85, v85
    v_exp_f32 v86, v86
    v_exp_f32 v87, v87
    v_mfma_f32_32x32x16_bf16 v[136:151], a[44:47], v[100:103], v[136:151]
    v_cvt_pk_bf16_f32 v98, v84, v85
    v_cvt_pk_bf16_f32 v99, v86, v87
    v_exp_f32 v88, v88
    v_exp_f32 v89, v89
    v_exp_f32 v90, v90
    v_exp_f32 v91, v91
    v_mfma_f32_32x32x16_bf16 v[152:167], a[40:43], v[96:99], v[152:167]
    buffer_load_dwordx4 v21, s[24:27], s70 offen offset:1024 lds
    v_cvt_pk_bf16_f32 v100, v88, v89
    v_cvt_pk_bf16_f32 v101, v90, v91
    v_exp_f32 v92, v92
    v_exp_f32 v93, v93
    v_exp_f32 v94, v94
    v_exp_f32 v95, v95
    v_cvt_pk_bf16_f32 v102, v92, v93
    v_cvt_pk_bf16_f32 v103, v94, v95
    v_mfma_f32_32x32x16_bf16 v[80:95], a[48:51], v[40:43], 0
    v_exp_f32 v64, v64
    v_exp_f32 v65, v65
    v_exp_f32 v66, v66
    v_exp_f32 v67, v67
    v_mfma_f32_32x32x16_bf16 v[80:95], a[52:55], v[44:47], v[80:95]
    global_load_dwordx4 a[32:35], v7, s[64:65] offset:-4096 sc1
    v_cvt_pk_bf16_f32 v96, v64, v65
    v_cvt_pk_bf16_f32 v97, v66, v67
    v_exp_f32 v68, v68
    v_exp_f32 v69, v69
    v_exp_f32 v70, v70
    v_exp_f32 v71, v71
    v_mfma_f32_32x32x16_bf16 v[152:167], a[44:47], v[100:103], v[152:167]
    s_waitcnt vmcnt(22)
    v_cvt_pk_bf16_f32 v98, v68, v69
    v_cvt_pk_bf16_f32 v99, v70, v71
    v_exp_f32 v72, v72
    v_exp_f32 v73, v73
    v_exp_f32 v74, v74
    v_exp_f32 v75, v75
    v_mfma_f32_32x32x16_bf16 v[104:119], a[56:59], v[96:99], v[104:119]
    global_load_dwordx4 a[36:39], v7, s[64:65] offset:-3072 sc1
    v_cvt_pk_bf16_f32 v100, v72, v73
    v_cvt_pk_bf16_f32 v101, v74, v75
    v_exp_f32 v76, v76
    v_exp_f32 v77, v77
    v_exp_f32 v78, v78
    v_exp_f32 v79, v79
    v_cvt_pk_bf16_f32 v102, v76, v77
    v_cvt_pk_bf16_f32 v103, v78, v79
    v_mfma_f32_32x32x16_bf16 v[64:79], a[48:51], v[48:51], 0
    v_exp_f32 v80, v80
    v_exp_f32 v81, v81
    v_exp_f32 v82, v82
    v_exp_f32 v83, v83
    v_mfma_f32_32x32x16_bf16 v[64:79], a[52:55], v[52:55], v[64:79]
    global_load_dwordx4 a[40:43], v7, s[64:65] offset:-2048 sc1
    v_cvt_pk_bf16_f32 v96, v80, v81
    v_cvt_pk_bf16_f32 v97, v82, v83
    v_exp_f32 v84, v84
    v_exp_f32 v85, v85
    v_exp_f32 v86, v86
    v_exp_f32 v87, v87
    v_mfma_f32_32x32x16_bf16 v[104:119], a[60:63], v[100:103], v[104:119]
    v_cvt_pk_bf16_f32 v98, v84, v85
    v_cvt_pk_bf16_f32 v99, v86, v87
    v_exp_f32 v88, v88
    v_exp_f32 v89, v89
    v_exp_f32 v90, v90
    v_exp_f32 v91, v91
    v_mfma_f32_32x32x16_bf16 v[120:135], a[56:59], v[96:99], v[120:135]
    global_load_dwordx4 a[44:47], v7, s[64:65] offset:-1024 sc1
    v_cvt_pk_bf16_f32 v100, v88, v89
    v_cvt_pk_bf16_f32 v101, v90, v91
    v_exp_f32 v92, v92
    v_exp_f32 v93, v93
    v_exp_f32 v94, v94
    v_exp_f32 v95, v95
    v_cvt_pk_bf16_f32 v102, v92, v93
    v_cvt_pk_bf16_f32 v103, v94, v95
    v_mfma_f32_32x32x16_bf16 v[80:95], a[48:51], v[56:59], 0
    v_exp_f32 v64, v64
    v_exp_f32 v65, v65
    v_exp_f32 v66, v66
    v_exp_f32 v67, v67
    v_mfma_f32_32x32x16_bf16 v[80:95], a[52:55], v[60:63], v[80:95]
    buffer_load_dword v13, v16, s[16:19], 0 offen sc1
    v_cvt_pk_bf16_f32 v96, v64, v65
    v_cvt_pk_bf16_f32 v97, v66, v67
    v_exp_f32 v68, v68
    v_exp_f32 v69, v69
    v_exp_f32 v70, v70
    v_exp_f32 v71, v71
    v_mfma_f32_32x32x16_bf16 v[120:135], a[60:63], v[100:103], v[120:135]
    s_waitcnt vmcnt(19)
    v_cvt_pk_bf16_f32 v98, v68, v69
    v_cvt_pk_bf16_f32 v99, v70, v71
    v_exp_f32 v72, v72
    v_exp_f32 v73, v73
    v_exp_f32 v74, v74
    v_exp_f32 v75, v75
    v_mfma_f32_32x32x16_bf16 v[136:151], a[56:59], v[96:99], v[136:151]
    buffer_load_dwordx4 v22, s[24:27], s70 offen offset:2048 lds
    v_cvt_pk_bf16_f32 v100, v72, v73
    v_cvt_pk_bf16_f32 v101, v74, v75
    v_exp_f32 v76, v76
    v_exp_f32 v77, v77
    v_exp_f32 v78, v78
    v_exp_f32 v79, v79
    v_cvt_pk_bf16_f32 v102, v76, v77
    v_cvt_pk_bf16_f32 v103, v78, v79
    v_mfma_f32_32x32x16_bf16 v[64:79], a[0:3], v[32:35], 0
    v_exp_f32 v80, v80
    v_exp_f32 v81, v81
    v_exp_f32 v82, v82
    v_exp_f32 v83, v83
    v_mfma_f32_32x32x16_bf16 v[64:79], a[4:7], v[36:39], v[64:79]
    buffer_load_dwordx4 v23, s[24:27], s70 offen offset:3072 lds
    v_cvt_pk_bf16_f32 v96, v80, v81
    v_cvt_pk_bf16_f32 v97, v82, v83
    v_exp_f32 v84, v84
    v_exp_f32 v85, v85
    v_exp_f32 v86, v86
    v_exp_f32 v87, v87
    v_mfma_f32_32x32x16_bf16 v[136:151], a[60:63], v[100:103], v[136:151]
    s_add_u32 m0, s60, 118784
    v_cvt_pk_bf16_f32 v98, v84, v85
    v_cvt_pk_bf16_f32 v99, v86, v87
    v_exp_f32 v88, v88
    v_exp_f32 v89, v89
    v_exp_f32 v90, v90
    v_exp_f32 v91, v91
    v_mfma_f32_32x32x16_bf16 v[152:167], a[56:59], v[96:99], v[152:167]
    buffer_load_dwordx4 v20, s[24:27], s71 offen offset:0 lds
    v_cvt_pk_bf16_f32 v100, v88, v89
    v_cvt_pk_bf16_f32 v101, v90, v91
    v_exp_f32 v92, v92
    v_exp_f32 v93, v93
    v_exp_f32 v94, v94
    v_exp_f32 v95, v95
    v_cvt_pk_bf16_f32 v102, v92, v93
    v_cvt_pk_bf16_f32 v103, v94, v95
    v_mfma_f32_32x32x16_bf16 v[80:95], a[0:3], v[40:43], 0
    s_waitcnt vmcnt(3)
    s_mov_b32 s35, 0
L_f_pollB:
    v_cmp_ne_u32 vcc, s67, v13
    s_cbranch_vccz L_f_pollB_done
    buffer_load_dword v13, v16, s[16:19], 0 offen sc1
    s_add_u32 s35, s35, 1
    s_cmp_lt_u32 s35, 262144
    s_waitcnt vmcnt(0)
    s_cbranch_scc1 L_f_pollB
L_f_pollB_done:
    v_exp_f32 v64, v64
    v_exp_f32 v65, v65
    v_exp_f32 v66, v66
    v_exp_f32 v67, v67
    v_mfma_f32_32x32x16_bf16 v[80:95], a[4:7], v[44:47], v[80:95]
    global_load_dwordx4 a[48:51], v7, s[64:65] offset:0 sc1
    v_cvt_pk_bf16_f32 v96, v64, v65
    v_cvt_pk_bf16_f32 v97, v66, v67
    v_exp_f32 v68, v68
    v_exp_f32 v69, v69
    v_exp_f32 v70, v70
    v_exp_f32 v71, v71
    v_mfma_f32_32x32x16_bf16 v[152:167], a[60:63], v[100:103], v[152:167]
    v_cvt_pk_bf16_f32 v98, v68, v69
    v_cvt_pk_bf16_f32 v99, v70, v71
    v_exp_f32 v72, v72
    v_exp_f32 v73, v73
    v_exp_f32 v74, v74
    v_exp_f32 v75, v75
    v_mfma_f32_32x32x16_bf16 v[104:119], a[8:11], v[96:99], v[104:119]
    global_load_dwordx4 a[52:55], v7, s[64:65] offset:1024 sc1
    v_cvt_pk_bf16_f32 v100, v72, v73
    v_cvt_pk_bf16_f32 v101, v74, v75
    v_exp_f32 v76, v76
    v_exp_f32 v77, v77
    v_exp_f32 v78, v78
    v_exp_f32 v79, v79
    v_cvt_pk_bf16_f32 v102, v76, v77
    v_cvt_pk_bf16_f32 v103, v78, v79
    v_mfma_f32_32x32x16_bf16 v[64:79], a[0:3], v[48:51], 0
    v_exp_f32 v80, v80
    v_exp_f32 v81, v81
    v_exp_f32 v82, v82
    v_exp_f32 v83, v83
    v_mfma_f32_32x32x16_bf16 v[64:79], a[4:7], v[52:55], v[64:79]
    global_load_dwordx4 a[56:59], v7, s[64:65] offset:2048 sc1
    v_cvt_pk_bf16_f32 v96, v80, v81
    v_cvt_pk_bf16_f32 v97, v82, v83
    v_exp_f32 v84, v84
    v_exp_f32 v85, v85
    v_exp_f32 v86, v86
    v_exp_f32 v87, v87
    v_mfma_f32_32x32x16_bf16 v[104:119], a[12:15], v[100:103], v[104:119]
    v_cvt_pk_bf16_f32 v98, v84, v85
    v_cvt_pk_bf16_f32 v99, v86, v87
    v_exp_f32 v88, v88
    v_exp_f32 v89, v89
    v_exp_f32 v90, v90
    v_exp_f32 v91, v91
    v_mfma_f32_32x32x16_bf16 v[120:135], a[8:11], v[96:99], v[120:135]
    global_load_dwordx4 a[60:63], v7, s[64:65] offset:3072 sc1
    v_cvt_pk_bf16_f32 v100, v88, v89
    v_cvt_pk_bf16_f32 v101, v90, v91
    v_exp_f32 v92, v92
    v_exp_f32 v93, v93
    v_exp_f32 v94, v94
    v_exp_f32 v95, v95
    v_cvt_pk_bf16_f32 v102, v92, v93
    v_cvt_pk_bf16_f32 v103, v94, v95
    v_mfma_f32_32x32x16_bf16 v[80:95], a[0:3], v[56:59], 0
    v_exp_f32 v64, v64
    v_exp_f32 v65, v65
    v_exp_f32 v66, v66
    v_exp_f32 v67, v67
    v_mfma_f32_32x32x16_bf16 v[80:95], a[4:7], v[60:63], v[80:95]
    global_load_dwordx4 a[192:195], v9, s[64:65] offset:-4096 sc1
    v_cvt_pk_bf16_f32 v96, v64, v65
    v_cvt_pk_bf16_f32 v97, v66, v67
    v_exp_f32 v68, v68
    v_exp_f32 v69, v69
    v_exp_f32 v70, v70
    v_exp_f32 v71, v71
    v_mfma_f32_32x32x16_bf16 v[120:135], a[12:15], v[100:103], v[120:135]
    v_cvt_pk_bf16_f32 v98, v68, v69
    v_cvt_pk_bf16_f32 v99, v70, v71
    v_exp_f32 v72, v72
    v_exp_f32 v73, v73
    v_exp_f32 v74, v74
    v_exp_f32 v75, v75
    v_mfma_f32_32x32x16_bf16 v[136:151], a[8:11], v[96:99], v[136:151]
    global_load_dwordx4 a[196:199], v9, s[64:65] offset:-3072 sc1
    v_cvt_pk_bf16_f32 v100, v72, v73
    v_cvt_pk_bf16_f32 v101, v74, v75
    v_exp_f32 v76, v76
    v_exp_f32 v77, v77
    v_exp_f32 v78, v78
    v_exp_f32 v79, v79
    v_cvt_pk_bf16_f32 v102, v76, v77
    v_cvt_pk_bf16_f32 v103, v78, v79
    v_mfma_f32_32x32x16_bf16 v[64:79], a[16:19], v[32:35], 0
    v_exp_f32 v80, v80
    v_exp_f32 v81, v81
    v_exp_f32 v82, v82
    v_exp_f32 v83, v83
    v_mfma_f32_32x32x16_bf16 v[64:79], a[20:23], v[36:39], v[64:79]
    global_load_dwordx4 a[200:203], v9, s[64:65] offset:-2048 sc1
    v_cvt_pk_bf16_f32 v96, v80, v81
    v_cvt_pk_bf16_f32 v97, v82, v83
    v_exp_f32 v84, v84
    v_exp_f32 v85, v85
    v_exp_f32 v86, v86
    v_exp_f32 v87, v87
    v_mfma_f32_32x32x16_bf16 v[136:151], a[12:15], v[100:103], v[136:151]
    v_cvt_pk_bf16_f32 v98, v84, v85
    v_cvt_pk_bf16_f32 v99, v86, v87
    v_exp_f32 v88, v88
    v_exp_f32 v89, v89
    v_exp_f32 v90, v90
    v_exp_f32 v91, v91
    v_mfma_f32_32x32x16_bf16 v[152:167], a[8:11], v[96:99], v[152:167]
    global_load_dwordx4 a[204:207], v9, s[64:65] offset:-1024 sc1
    v_cvt_pk_bf16_f32 v100, v88, v89
    v_cvt_pk_bf16_f32 v101, v90, v91
    v_exp_f32 v92, v92
    v_exp_f32 v93, v93
    v_exp_f32 v94, v94
    v_exp_f32 v95, v95
    v_cvt_pk_bf16_f32 v102, v92, v93
    v_cvt_pk_bf16_f32 v103, v94, v95
    v_mfma_f32_32x32x16_bf16 v[80:95], a[32:35], v[32:35], 0
    v_exp_f32 v64, v64
    v_exp_f32 v65, v65
    v_exp_f32 v66, v66
    v_exp_f32 v67, v67
    v_mfma_f32_32x32x16_bf16 v[80:95], a[36:39], v[36:39], v[80:95]
    global_load_dwordx4 a[208:211], v9, s[64:65] offset:0 sc1
    v_cvt_pk_bf16_f32 v96, v64, v65
    v_cvt_pk_bf16_f32 v97, v66, v67
    v_exp_f32 v68, v68
    v_exp_f32 v69, v69
    v_exp_f32 v70, v70
    v_exp_f32 v71, v71
    v_mfma_f32_32x32x16_bf16 v[152:167], a[12:15], v[100:103], v[152:167]
    s_waitcnt vmcnt(7)
    v_cvt_pk_bf16_f32 v98, v68, v69
    v_cvt_pk_bf16_f32 v99, v70, v71
    v_exp_f32 v72, v72
    v_exp_f32 v73, v73
    v_exp_f32 v74, v74
    v_exp_f32 v75, v75
    v_mfma_f32_32x32x16_bf16 v[104:119], a[24:27], v[96:99], v[104:119]
    global_load_dwordx4 a[212:215], v9, s[64:65] offset:1024 sc1
    v_cvt_pk_bf16_f32 v100, v72, v73
    v_cvt_pk_bf16_f32 v101, v74, v75
    v_exp_f32 v76, v76
    v_exp_f32 v77, v77
    v_exp_f32 v78, v78
    v_exp_f32 v79, v79
    v_cvt_pk_bf16_f32 v102, v76, v77
    v_cvt_pk_bf16_f32 v103, v78, v79
    v_mfma_f32_32x32x16_bf16 v[64:79], a[48:51], v[32:35], 0
    v_exp_f32 v80, v80
    v_exp_f32 v81, v81
    v_exp_f32 v82, v82
    v_exp_f32 v83, v83
    v_mfma_f32_32x32x16_bf16 v[64:79], a[52:55], v[36:39], v[64:79]
    global_load_dwordx4 a[216:219], v9, s[64:65] offset:2048 sc1
    v_cvt_pk_bf16_f32 v96, v80, v81
    v_cvt_pk_bf16_f32 v97, v82, v83
    v_exp_f32 v84, v84
    v_exp_f32 v85, v85
    v_exp_f32 v86, v86
    v_exp_f32 v87, v87
    v_mfma_f32_32x32x16_bf16 v[104:119], a[28:31], v[100:103], v[104:119]
    v_cvt_pk_bf16_f32 v98, v84, v85
    v_cvt_pk_bf16_f32 v99, v86, v87
    v_exp_f32 v88, v88
    v_exp_f32 v89, v89
    v_exp_f32 v90, v90
    v_exp_f32 v91, v91
    v_mfma_f32_32x32x16_bf16 v[104:119], a[40:43], v[96:99], v[104:119]
    global_load_dwordx4 a[220:223], v9, s[64:65] offset:3072 sc1
    v_add_u32 v9, 0x2000, v9
    v_cvt_pk_bf16_f32 v100, v88, v89
    v_cvt_pk_bf16_f32 v101, v90, v91
    v_exp_f32 v92, v92
    v_exp_f32 v93, v93
    v_exp_f32 v94, v94
    v_exp_f32 v95, v95
    v_cvt_pk_bf16_f32 v102, v92, v93
    v_cvt_pk_bf16_f32 v103, v94, v95
    v_mfma_f32_32x32x16_bf16 v[80:95], a[16:19], v[40:43], 0
    v_exp_f32 v64, v64
    v_exp_f32 v65, v65
    v_exp_f32 v66, v66
    v_exp_f32 v67, v67
    v_mfma_f32_32x32x16_bf16 v[80:95], a[20:23], v[44:47], v[80:95]
    global_load_dwordx4 a[224:227], v9, s[64:65] offset:-4096 sc1
    v_cvt_pk_bf16_f32 v96, v64, v65
    v_cvt_pk_bf16_f32 v97, v66, v67
    v_exp_f32 v68, v68
    v_exp_f32 v69, v69
    v_exp_f32 v70, v70
    v_exp_f32 v71, v71
    v_mfma_f32_32x32x16_bf16 v[104:119], a[44:47], v[100:103], v[104:119]
    s_waitcnt vmcnt(9)
    v_cvt_pk_bf16_f32 v98, v68, v69
    v_cvt_pk_bf16_f32 v99, v70, v71
    v_exp_f32 v72, v72
    v_exp_f32 v73, v73
    v_exp_f32 v74, v74
    v_exp_f32 v75, v75
    v_mfma_f32_32x32x16_bf16 v[104:119], a[56:59], v[96:99], v[104:119]
    global_load_dwordx4 a[228:231], v9, s[64:65] offset:-3072 sc1
    v_cvt_pk_bf16_f32 v100, v72, v73
    v_cvt_pk_bf16_f32 v101, v74, v75
    v_exp_f32 v76, v76
    v_exp_f32 v77, v77
    v_exp_f32 v78, v78
    v_exp_f32 v79, v79
    v_cvt_pk_bf16_f32 v102, v76, v77
    v_cvt_pk_bf16_f32 v103, v78, v79
    v_mfma_f32_32x32x16_bf16 v[64:79], a[32:35], v[40:43], 0
    v_exp_f32 v80, v80
    v_exp_f32 v81, v81
    v_exp_f32 v82, v82
    v_exp_f32 v83, v83
    v_mfma_f32_32x32x16_bf16 v[64:79], a[36:39], v[44:47], v[64:79]
    global_load_dwordx4 a[232:235], v9, s[64:65] offset:-2048 sc1
    v_cvt_pk_bf16_f32 v96, v80, v81
    v_cvt_pk_bf16_f32 v97, v82, v83
    v_exp_f32 v84, v84
    v_exp_f32 v85, v85
    v_exp_f32 v86, v86
    v_exp_f32 v87, v87
    v_mfma_f32_32x32x16_bf16 v[104:119], a[60:63], v[100:103], v[104:119]
    v_cvt_pk_bf16_f32 v98, v84, v85
    v_cvt_pk_bf16_f32 v99, v86, v87
    v_exp_f32 v88, v88
    v_exp_f32 v89, v89
    v_exp_f32 v90, v90
    v_exp_f32 v91, v91
    v_mfma_f32_32x32x16_bf16 v[120:135], a[24:27], v[96:99], v[120:135]
    global_load_dwordx4 a[236:239], v9, s[64:65] offset:-1024 sc1
    v_add_u32 v11, s72, v6
    v_cvt_pk_bf16_f32 v100, v88, v89
    v_cvt_pk_bf16_f32 v101, v90, v91
    v_exp_f32 v92, v92
    v_exp_f32 v93, v93
    v_exp_f32 v94, v94
    v_exp_f32 v95, v95
    v_cvt_pk_bf16_f32 v102, v92, v93
    v_cvt_pk_bf16_f32 v103, v94, v95
    v_mfma_f32_32x32x16_bf16 v[80:95], a[48:51], v[40:43], 0
    ds_write_b128 v11, v[104:107] offset:0
    v_exp_f32 v64, v64
    v_exp_f32 v65, v65
    v_exp_f32 v66, v66
    v_exp_f32 v67, v67
    v_mfma_f32_32x32x16_bf16 v[80:95], a[52:55], v[44:47], v[80:95]
    ds_write_b128 v11, v[108:111] offset:1024
    v_cvt_pk_bf16_f32 v96, v64, v65
    v_cvt_pk_bf16_f32 v97, v66, v67
    v_exp_f32 v68, v68
L_f_pad12:
    s_cbranch_execz L_f_tdone
    v_exp_f32 v69, v69
    v_exp_f32 v70, v70
    v_exp_f32 v71, v71
    v_mfma_f32_32x32x16_bf16 v[120:135], a[28:31], v[100:103], v[120:135]
    ds_write_b128 v11, v[112:115] offset:2048
    v_cvt_pk_bf16_f32 v98, v68, v69
    v_cvt_pk_bf16_f32 v99, v70, v71
    v_exp_f32 v72, v72
    v_exp_f32 v73, v73
    v_exp_f32 v74, v74
    v_exp_f32 v75, v75
    v_mfma_f32_32x32x16_bf16 v[120:135], a[40:43], v[96:99], v[120:135]
    ds_write_b128 v11, v[116:119] offset:3072
    v_cvt_pk_bf16_f32 v100, v72, v73
    v_cvt_pk_bf16_f32 v101, v74, v75
    v_exp_f32 v76, v76
    v_exp_f32 v77, v77
    v_exp_f32 v78, v78
    v_exp_f32 v79, v79
    v_cvt_pk_bf16_f32 v102, v76, v77
    v_cvt_pk_bf16_f32 v103, v78, v79
    v_mfma_f32_32x32x16_bf16 v[64:79], a[16:19], v[48:51], 0
    global_load_dwordx4 a[240:243], v9, s[64:65] offset:0 sc1
    v_exp_f32 v80, v80
    v_exp_f32 v81, v81
    v_exp_f32 v82, v82
    v_exp_f32 v83, v83
    v_mfma_f32_32x32x16_bf16 v[64:79], a[20:23], v[52:55], v[64:79]
    v_cvt_pk_bf16_f32 v96, v80, v81
    v_cvt_pk_bf16_f32 v97, v82, v83
    v_exp_f32 v84, v84
    v_exp_f32 v85, v85
    v_exp_f32 v86, v86
    v_exp_f32 v87, v87
    v_mfma_f32_32x32x16_bf16 v[120:135], a[44:47], v[100:103], v[120:135]
    v_cvt_pk_bf16_f32 v98, v84, v85
    v_cvt_pk_bf16_f32 v99, v86, v87
    v_exp_f32 v88, v88
    v_exp_f32 v89, v89
    v_exp_f32 v90, v90
    v_exp_f32 v91, v91
    v_mfma_f32_32x32x16_bf16 v[120:135], a[56:59], v[96:99], v[120:135]
    global_load_dwordx4 a[244:247], v9, s[64:65] offset:1024 sc1
    v_cvt_pk_bf16_f32 v100, v88, v89
    v_cvt_pk_bf16_f32 v101, v90, v91
    v_exp_f32 v92, v92
    v_exp_f32 v93, v93
    v_exp_f32 v94, v94
    v_exp_f32 v95, v95
    v_cvt_pk_bf16_f32 v102, v92, v93
    v_cvt_pk_bf16_f32 v103, v94, v95
    v_mfma_f32_32x32x16_bf16 v[80:95], a[32:35], v[48:51], 0
    v_exp_f32 v64, v64
    v_exp_f32 v65, v65
    v_exp_f32 v66, v66
    v_exp_f32 v67, v67
    v_mfma_f32_32x32x16_bf16 v[80:95], a[36:39], v[52:55], v[80:95]
    global_load_dwordx4 a[248:251], v9, s[64:65] offset:2048 sc1
    v_cvt_pk_bf16_f32 v96, v64, v65
    v_cvt_pk_bf16_f32 v97, v66, v67
    v_exp_f32 v68, v68
    v_exp_f32 v69, v69
    v_exp_f32 v70, v70
    v_exp_f32 v71, v71
    v_mfma_f32_32x32x16_bf16 v[120:135], a[60:63], v[100:103], v[120:135]
    v_cvt_pk_bf16_f32 v98, v68, v69
    v_cvt_pk_bf16_f32 v99, v70, v71
    v_exp_f32 v72, v72
    v_exp_f32 v73, v73
    v_exp_f32 v74, v74
    v_exp_f32 v75, v75
    v_mfma_f32_32x32x16_bf16 v[136:151], a[24:27], v[96:99], v[136:151]
    global_load_dwordx4 a[252:255], v9, s[64:65] offset:3072 sc1
    v_add_u32 v11, s73, v6
    v_cvt_pk_bf16_f32 v100, v72, v73
    v_cvt_pk_bf16_f32 v101, v74, v75
    v_exp_f32 v76, v76
    v_exp_f32 v77, v77
    v_exp_f32 v78, v78
    v_exp_f32 v79, v79
    v_cvt_pk_bf16_f32 v102, v76, v77
    v_cvt_pk_bf16_f32 v103, v78, v79
    v_mfma_f32_32x32x16_bf16 v[64:79], a[48:51], v[48:51], 0
    ds_write_b128 v11, v[120:123] offset:4096
    v_exp_f32 v80, v80
    v_exp_f32 v81, v81
    v_exp_f32 v82, v82
    v_exp_f32 v83, v83
    v_mfma_f32_32x32x16_bf16 v[64:79], a[52:55], v[52:55], v[64:79]
    ds_write_b128 v11, v[124:127] offset:5120
    v_cvt_pk_bf16_f32 v96, v80, v81
    v_cvt_pk_bf16_f32 v97, v82, v83
    v_exp_f32 v84, v84
    v_exp_f32 v85, v85
    v_exp_f32 v86, v86
    v_exp_f32 v87, v87
    v_mfma_f32_32x32x16_bf16 v[136:151], a[28:31], v[100:103], v[136:151]
    ds_write_b128 v11, v[128:131] offset:6144
    v_cvt_pk_bf16_f32 v98, v84, v85
    v_cvt_pk_bf16_f32 v99, v86, v87
    v_exp_f32 v88, v88
    v_exp_f32 v89, v89
    v_exp_f32 v90, v90
    v_exp_f32 v91, v91
    v_mfma_f32_32x32x16_bf16 v[136:151], a[40:43], v[96:99], v[136:151]
    ds_write_b128 v11, v[132:135] offset:7168
    v_cvt_pk_bf16_f32 v100, v88, v89
    v_cvt_pk_bf16_f32 v101, v90, v91
    v_exp_f32 v92, v92
    v_exp_f32 v93, v93
    v_exp_f32 v94, v94
    v_exp_f32 v95, v95
    v_cvt_pk_bf16_f32 v102, v92, v93
    v_cvt_pk_bf16_f32 v103, v94, v95
    v_mfma_f32_32x32x16_bf16 v[80:95], a[16:19], v[56:59], 0
    buffer_load_dwordx4 v21, s[24:27], s71 offen offset:1024 lds
    v_exp_f32 v64, v64
    v_exp_f32 v65, v65
    v_exp_f32 v66, v66
    v_exp_f32 v67, v67
    v_mfma_f32_32x32x16_bf16 v[80:95], a[20:23], v[60:63], v[80:95]
    v_cvt_pk_bf16_f32 v96, v64, v65
    v_cvt_pk_bf16_f32 v97, v66, v67
    v_exp_f32 v68, v68
    v_exp_f32 v69, v69
    v_exp_f32 v70, v70
    v_exp_f32 v71, v71
    v_mfma_f32_32x32x16_bf16 v[136:151], a[44:47], v[100:103], v[136:151]
    v_cvt_pk_bf16_f32 v98, v68, v69
    v_cvt_pk_bf16_f32 v99, v70, v71
    v_exp_f32 v72, v72
    v_exp_f32 v73, v73
    v_exp_f32 v74, v74
    v_exp_f32 v75, v75
    v_mfma_f32_32x32x16_bf16 v[136:151], a[56:59], v[96:99], v[136:151]
    v_cvt_pk_bf16_f32 v100, v72, v73
    v_cvt_pk_bf16_f32 v101, v74, v75
    v_exp_f32 v76, v76
    v_exp_f32 v77, v77
    v_exp_f32 v78, v78
    v_exp_f32 v79, v79
    v_cvt_pk_bf16_f32 v102, v76, v77
    v_cvt_pk_bf16_f32 v103, v78, v79
    v_mfma_f32_32x32x16_bf16 v[64:79], a[32:35], v[56:59], 0
    v_exp_f32 v80, v80
    v_exp_f32 v81, v81
    v_exp_f32 v82, v82
    v_exp_f32 v83, v83
    v_mfma_f32_32x32x16_bf16 v[64:79], a[36:39], v[60:63], v[64:79]
    v_cvt_pk_bf16_f32 v96, v80, v81
    v_cvt_pk_bf16_f32 v97, v82, v83
    v_exp_f32 v84, v84
    v_exp_f32 v85, v85
    v_exp_f32 v86, v86
    v_exp_f32 v87, v87
    v_mfma_f32_32x32x16_bf16 v[136:151], a[60:63], v[100:103], v[136:151]
    v_cvt_pk_bf16_f32 v98, v84, v85
    v_cvt_pk_bf16_f32 v99, v86, v87
    v_exp_f32 v88, v88
    v_exp_f32 v89, v89
    v_exp_f32 v90, v90
    v_exp_f32 v91, v91
    v_mfma_f32_32x32x16_bf16 v[152:167], a[24:27], v[96:99], v[152:167]
    v_add_u32 v11, s74, v6
    v_cvt_pk_bf16_f32 v100, v88, v89
    v_cvt_pk_bf16_f32 v101, v90, v91
    v_exp_f32 v92, v92
    v_exp_f32 v93, v93
    v_exp_f32 v94, v94
    v_exp_f32 v95, v95
    v_cvt_pk_bf16_f32 v102, v92, v93
    v_cvt_pk_bf16_f32 v103, v94, v95
    v_mfma_f32_32x32x16_bf16 v[80:95], a[48:51], v[56:59], 0
    ds_write_b128 v11, v[136:139] offset:8192
    v_exp_f32 v64, v64
    v_exp_f32 v65, v65
    v_exp_f32 v66, v66
    v_exp_f32 v67, v67
    v_mfma_f32_32x32x16_bf16 v[80:95], a[52:55], v[60:63], v[80:95]
    ds_write_b128 v11, v[140:143] offset:9216
    v_cvt_pk_bf16_f32 v96, v64, v65
    v_cvt_pk_bf16_f32 v97, v66, v67
    v_exp_f32 v68, v68
    v_exp_f32 v69, v69
    v_exp_f32 v70, v70
    v_exp_f32 v71, v71
    v_mfma_f32_32x32x16_bf16 v[152:167], a[28:31], v[100:103], v[152:167]
    ds_write_b128 v11, v[144:147] offset:10240
    v_cvt_pk_bf16_f32 v98, v68, v69
    v_cvt_pk_bf16_f32 v99, v70, v71
    v_exp_f32 v72, v72
    v_exp_f32 v73, v73
    v_exp_f32 v74, v74
    v_exp_f32 v75, v75
    v_mfma_f32_32x32x16_bf16 v[152:167], a[40:43], v[96:99], v[152:167]
    ds_write_b128 v11, v[148:151] offset:11264
    v_cvt_pk_bf16_f32 v100, v72, v73
    v_cvt_pk_bf16_f32 v101, v74, v75
    v_exp_f32 v76, v76
    v_exp_f32 v77, v77
    v_exp_f32 v78, v78
    v_exp_f32 v79, v79
    v_cvt_pk_bf16_f32 v102, v76, v77
    v_cvt_pk_bf16_f32 v103, v78, v79
    s_waitcnt lgkmcnt(0)
    s_barrier
    v_exp_f32 v80, v80
    v_exp_f32 v81, v81
    v_exp_f32 v82, v82
    v_exp_f32 v83, v83
    ds_read_b128 v[168:171], v12 offset:0
    ds_read_b128 v[172:175], v12 offset:1024
    ds_read_b128 v[176:179], v12 offset:2048
    ds_read_b128 v[180:183], v12 offset:3072
    v_cvt_pk_bf16_f32 v96, v80, v81
    v_cvt_pk_bf16_f32 v97, v82, v83
    v_exp_f32 v84, v84
    v_exp_f32 v85, v85
    v_exp_f32 v86, v86
    v_exp_f32 v87, v87
    v_mfma_f32_32x32x16_bf16 v[152:167], a[44:47], v[100:103], v[152:167]
    ds_read_b128 v[184:187], v12 offset:4096
    ds_read_b128 v[188:191], v12 offset:5120
    ds_read_b128 v[192:195], v12 offset:6144
    ds_read_b128 v[196:199], v12 offset:7168
    v_cvt_pk_bf16_f32 v98, v84, v85
    v_cvt_pk_bf16_f32 v99, v86, v87
    v_exp_f32 v88, v88
    v_exp_f32 v89, v89
    v_exp_f32 v90, v90
    v_exp_f32 v91, v91
    v_mfma_f32_32x32x16_bf16 v[152:167], a[56:59], v[96:99], v[152:167]
    ds_read_b128 v[200:203], v12 offset:8192
    ds_read_b128 v[204:207], v12 offset:9216
    ds_read_b128 v[208:211], v12 offset:10240
    ds_read_b128 v[212:215], v12 offset:11264
    v_cvt_pk_bf16_f32 v100, v88, v89
    v_cvt_pk_bf16_f32 v101, v90, v91
    v_exp_f32 v92, v92
    v_exp_f32 v93, v93
    v_exp_f32 v94, v94
    v_exp_f32 v95, v95
    v_cvt_pk_bf16_f32 v102, v92, v93
    v_cvt_pk_bf16_f32 v103, v94, v95
    s_nop 1
    v_mfma_f32_32x32x16_bf16 v[152:167], a[60:63], v[100:103], v[152:167]
    s_waitcnt lgkmcnt(4)
    v_pk_add_f32 v[168:169], v[168:169], v[184:185]
    v_pk_add_f32 v[170:171], v[170:171], v[186:187]
    v_pk_add_f32 v[172:173], v[172:173], v[188:189]
    v_pk_add_f32 v[174:175], v[174:175], v[190:191]
    v_pk_add_f32 v[176:177], v[176:177], v[192:193]
    v_pk_add_f32 v[178:179], v[178:179], v[194:195]
    v_pk_add_f32 v[180:181], v[180:181], v[196:197]
    v_pk_add_f32 v[182:183], v[182:183], v[198:199]
    s_waitcnt lgkmcnt(0)
    v_pk_add_f32 v[168:169], v[168:169], v[200:201]
    v_pk_add_f32 v[170:171], v[170:171], v[202:203]
    v_pk_add_f32 v[172:173], v[172:173], v[204:205]
    v_pk_add_f32 v[174:175], v[174:175], v[206:207]
    v_pk_add_f32 v[176:177], v[176:177], v[208:209]
    v_pk_add_f32 v[178:179], v[178:179], v[210:211]
    v_pk_add_f32 v[180:181], v[180:181], v[212:213]
    v_pk_add_f32 v[182:183], v[182:183], v[214:215]
    v_pk_add_f32 v[152:153], v[152:153], v[168:169]
    v_pk_add_f32 v[154:155], v[154:155], v[170:171]
    v_pk_add_f32 v[156:157], v[156:157], v[172:173]
    v_pk_add_f32 v[158:159], v[158:159], v[174:175]
    v_pk_add_f32 v[160:161], v[160:161], v[176:177]
    v_pk_add_f32 v[162:163], v[162:163], v[178:179]
    v_pk_add_f32 v[164:165], v[164:165], v[180:181]
    v_pk_add_f32 v[166:167], v[166:167], v[182:183]
    v_mov_b32 v3, v164
    v_pk_mul_f32 v[30:31], v[152:153], 0
    v_pk_fma_f32 v[30:31], v[154:155], 0, v[30:31]
    v_pk_fma_f32 v[30:31], v[156:157], 0, v[30:31]
    v_pk_fma_f32 v[30:31], v[158:159], 0, v[30:31]
    v_pk_fma_f32 v[30:31], v[160:161], 0, v[30:31]
    v_pk_fma_f32 v[30:31], v[162:163], 0, v[30:31]
    v_pk_fma_f32 v[30:31], v[164:165], 0, v[30:31]
    v_pk_fma_f32 v[30:31], v[166:167], 0, v[30:31]
    v_permlane32_swap_b32 v164, v3
    v_add_f32 v4, v30, v31
    v_add_f32 v4, v4, v3
    v_cmp_le_f32 vcc, 0x21800000, v4
    s_mov_b32 s41, 0x5d800000
    v_cmp_ge_f32 s[50:51], s41, v4
    v_rcp_f32 v3, v3
    s_and_b64 vcc, vcc, s[50:51]
    s_cmp_eq_u64 vcc, -1
    s_cselect_b32 s46, 1, 0
    v_mul_f32 v3, v3, v10
    s_cbranch_scc0 L_f_vote
    v_mul_f32 v152, v3, v152
    v_mul_f32 v153, v3, v153
    v_mul_f32 v154, v3, v154
    v_mul_f32 v155, v3, v155
    v_mul_f32 v156, v3, v156
    v_mul_f32 v157, v3, v157
    v_mul_f32 v158, v3, v158
    v_mul_f32 v159, v3, v159
    v_mul_f32 v160, v3, v160
    v_mul_f32 v161, v3, v161
    v_mul_f32 v162, v3, v162
    v_mul_f32 v163, v3, v163
    v_mul_f32 v164, v3, v164
    v_mul_f32 v165, v3, v165
    v_mul_f32 v166, v3, v166
    v_mul_f32 v167, v3, v167
    v_cvt_pk_bf16_f32 v240, v152, v153
    v_cvt_pk_bf16_f32 v241, v154, v155
    v_cvt_pk_bf16_f32 v242, v156, v157
    v_cvt_pk_bf16_f32 v243, v158, v159
    buffer_store_dwordx4 v[240:243], v6, s[16:19], s61 offen sc1
    v_cvt_pk_bf16_f32 v244, v160, v161
    v_cvt_pk_bf16_f32 v245, v162, v163
    s_mov_b64 exec, 0xffffffff
    v_cvt_pk_bf16_f32 v246, v164, v165
    v_cvt_pk_bf16_f32 v247, v166, v167
    s_mov_b64 exec, -1
    buffer_store_dwordx4 v[244:247], v6, s[16:19], s61 offen offset:1024 sc1
L_f_vote:
    v_mov_b32 v3, s46
    v_and_b32 v4, 3, v1
    v_mul_u32_u24 v4, 12288, v4
    s_mov_b64 exec, 1
    ds_write_b32 v12, v3
    s_mov_b64 exec, -1
    s_waitcnt vmcnt(2) lgkmcnt(0)
    s_barrier
    ds_read_b32 v2, v4
    s_waitcnt lgkmcnt(0)
    v_cmp_eq_u32 vcc, 0, v2
    s_cbranch_vccnz L_f_fb
L_f_tail:
    s_cmp_ge_u32 s58, 28
    s_cbranch_scc1 L_f_exit
    v_add_u32 v9, 0xffdfe000, v9
    v_add_u32 v5, 0x2000, v9
    s_mov_b32 s49, 0
    ds_read_b64_tr_b16 v[200:201], v24 offset:0
    ds_read_b64_tr_b16 v[202:203], v24 offset:1024
    ds_read_b64_tr_b16 v[204:205], v25 offset:0
    ds_read_b64_tr_b16 v[206:207], v25 offset:1024
    ds_read_b64_tr_b16 v[208:209], v24 offset:2048
    ds_read_b64_tr_b16 v[210:211], v24 offset:3072
    ds_read_b64_tr_b16 v[212:213], v25 offset:2048
    ds_read_b64_tr_b16 v[214:215], v25 offset:3072
    s_waitcnt lgkmcnt(6)
    v_mfma_f32_32x32x16_bf16 v[168:183], v[200:203], a[192:195], 0
    ds_read_b64_tr_b16 v[200:201], v24 offset:3584
    ds_read_b64_tr_b16 v[202:203], v24 offset:4608
    s_waitcnt lgkmcnt(6)
    v_mfma_f32_32x32x16_bf16 v[184:199], v[204:207], a[192:195], 0
    ds_read_b64_tr_b16 v[204:205], v25 offset:3584
    ds_read_b64_tr_b16 v[206:207], v25 offset:4608
    s_waitcnt lgkmcnt(6)
    v_mfma_f32_32x32x16_bf16 v[168:183], v[208:211], a[196:199], v[168:183]
    ds_read_b64_tr_b16 v[208:209], v24 offset:5632
    ds_read_b64_tr_b16 v[210:211], v24 offset:6656
    s_waitcnt lgkmcnt(6)
    v_mfma_f32_32x32x16_bf16 v[184:199], v[212:215], a[196:199], v[184:199]
    ds_read_b64_tr_b16 v[212:213], v25 offset:5632
    ds_read_b64_tr_b16 v[214:215], v25 offset:6656
    s_waitcnt lgkmcnt(6)
    v_mfma_f32_32x32x16_bf16 v[168:183], v[200:203], a[200:203], v[168:183]
    ds_read_b64_tr_b16 v[200:201], v24 offset:7168
    ds_read_b64_tr_b16 v[202:203], v24 offset:8192
    s_waitcnt lgkmcnt(6)
    v_mfma_f32_32x32x16_bf16 v[184:199], v[204:207], a[200:203], v[184:199]
    ds_read_b64_tr_b16 v[204:205], v25 offset:7168
    ds_read_b64_tr_b16 v[206:207], v25 offset:8192
    s_waitcnt lgkmcnt(6)
    v_mfma_f32_32x32x16_bf16 v[168:183], v[208:211], a[204:207], v[168:183]
    ds_read_b64_tr_b16 v[208:209], v24 offset:9216
    ds_read_b64_tr_b16 v[210:211], v24 offset:10240
    s_waitcnt lgkmcnt(6)
    v_mfma_f32_32x32x16_bf16 v[184:199], v[212:215], a[204:207], v[184:199]
    ds_read_b64_tr_b16 v[212:213], v25 offset:9216
    ds_read_b64_tr_b16 v[214:215], v25 offset:10240
    s_waitcnt lgkmcnt(6)
    v_mfma_f32_32x32x16_bf16 v[168:183], v[200:203], a[208:211], v[168:183]
    ds_read_b64_tr_b16 v[200:201], v24 offset:10752
    ds_read_b64_tr_b16 v[202:203], v24 offset:11776
    s_waitcnt lgkmcnt(6)
    v_mfma_f32_32x32x16_bf16 v[184:199], v[204:207], a[208:211], v[184:199]
    ds_read_b64_tr_b16 v[204:205], v25 offset:10752
    ds_read_b64_tr_b16 v[206:207], v25 offset:11776
    s_waitcnt lgkmcnt(6)
    v_mfma_f32_32x32x16_bf16 v[168:183], v[208:211], a[212:215], v[168:183]
    ds_read_b64_tr_b16 v[208:209], v24 offset:12800
    ds_read_b64_tr_b16 v[210:211], v24 offset:13824
    s_waitcnt lgkmcnt(6)
    v_mfma_f32_32x32x16_bf16 v[184:199], v[212:215], a[212:215], v[184:199]
    ds_read_b64_tr_b16 v[212:213], v25 offset:12800
    ds_read_b64_tr_b16 v[214:215], v25 offset:13824
    s_waitcnt lgkmcnt(6)
    v_mfma_f32_32x32x16_bf16 v[168:183], v[200:203], a[216:219], v[168:183]
    ds_read_b64_tr_b16 v[200:201], v24 offset:14336
    ds_read_b64_tr_b16 v[202:203], v24 offset:15360
    s_waitcnt lgkmcnt(6)
    v_mfma_f32_32x32x16_bf16 v[184:199], v[204:207], a[216:219], v[184:199]
    ds_read_b64_tr_b16 v[204:205], v25 offset:14336
    ds_read_b64_tr_b16 v[206:207], v25 offset:15360
    s_waitcnt lgkmcnt(6)
    v_mfma_f32_32x32x16_bf16 v[168:183], v[208:211], a[220:223], v[168:183]
    ds_read_b64_tr_b16 v[208:209], v24 offset:16384
    ds_read_b64_tr_b16 v[210:211], v24 offset:17408
    s_waitcnt lgkmcnt(6)
    v_mfma_f32_32x32x16_bf16 v[184:199], v[212:215], a[220:223], v[184:199]
    ds_read_b64_tr_b16 v[212:213], v25 offset:16384
    ds_read_b64_tr_b16 v[214:215], v25 offset:17408
    s_waitcnt lgkmcnt(6)
    v_mfma_f32_32x32x16_bf16 v[168:183], v[200:203], a[224:227], v[168:183]
    ds_read_b64_tr_b16 v[200:201], v24 offset:17920
    ds_read_b64_tr_b16 v[202:203], v24 offset:18944
    s_waitcnt lgkmcnt(6)
    v_mfma_f32_32x32x16_bf16 v[184:199], v[204:207], a[224:227], v[184:199]
    ds_read_b64_tr_b16 v[204:205], v25 offset:17920
    ds_read_b64_tr_b16 v[206:207], v25 offset:18944
    s_waitcnt lgkmcnt(6)
    v_mfma_f32_32x32x16_bf16 v[168:183], v[208:211], a[228:231], v[168:183]
    ds_read_b64_tr_b16 v[208:209], v24 offset:19968
    ds_read_b64_tr_b16 v[210:211], v24 offset:20992
    s_waitcnt lgkmcnt(6)
    v_mfma_f32_32x32x16_bf16 v[184:199], v[212:215], a[228:231], v[184:199]
    ds_read_b64_tr_b16 v[212:213], v25 offset:19968
    ds_read_b64_tr_b16 v[214:215], v25 offset:20992
    s_waitcnt lgkmcnt(6)
    v_mfma_f32_32x32x16_bf16 v[168:183], v[200:203], a[232:235], v[168:183]
    ds_read_b64_tr_b16 v[200:201], v24 offset:21504
    ds_read_b64_tr_b16 v[202:203], v24 offset:22528
    s_waitcnt lgkmcnt(6)
    v_mfma_f32_32x32x16_bf16 v[184:199], v[204:207], a[232:235], v[184:199]
    ds_read_b64_tr_b16 v[204:205], v25 offset:21504
    ds_read_b64_tr_b16 v[206:207], v25 offset:22528
    s_waitcnt lgkmcnt(6)
    v_mfma_f32_32x32x16_bf16 v[168:183], v[208:211], a[236:239], v[168:183]
    ds_read_b64_tr_b16 v[208:209], v24 offset:23552
    ds_read_b64_tr_b16 v[210:211], v24 offset:24576
    s_waitcnt lgkmcnt(6)
    v_mfma_f32_32x32x16_bf16 v[184:199], v[212:215], a[236:239], v[184:199]
    ds_read_b64_tr_b16 v[212:213], v25 offset:23552
    ds_read_b64_tr_b16 v[214:215], v25 offset:24576
    s_waitcnt lgkmcnt(6)
    v_mfma_f32_32x32x16_bf16 v[168:183], v[200:203], a[240:243], v[168:183]
    global_load_dwordx4 v[32:35], v9, s[64:65] offset:-4096 sc1
    global_load_dwordx4 v[36:39], v9, s[64:65] offset:-3072 sc1
    ds_read_b64_tr_b16 v[200:201], v24 offset:25088
    ds_read_b64_tr_b16 v[202:203], v24 offset:26112
    s_waitcnt lgkmcnt(6)
    v_mfma_f32_32x32x16_bf16 v[184:199], v[204:207], a[240:243], v[184:199]
    global_load_dwordx4 v[40:43], v9, s[64:65] offset:-2048 sc1
    global_load_dwordx4 v[44:47], v9, s[64:65] offset:-1024 sc1
    ds_read_b64_tr_b16 v[204:205], v25 offset:25088
    ds_read_b64_tr_b16 v[206:207], v25 offset:26112
    s_waitcnt lgkmcnt(6)
    v_mfma_f32_32x32x16_bf16 v[168:183], v[208:211], a[244:247], v[168:183]
    global_load_dwordx4 v[48:51], v9, s[64:65] offset:0 sc1
    global_load_dwordx4 v[52:55], v9, s[64:65] offset:1024 sc1
    ds_read_b64_tr_b16 v[208:209], v24 offset:27136
    ds_read_b64_tr_b16 v[210:211], v24 offset:28160
    s_waitcnt lgkmcnt(6)
    v_mfma_f32_32x32x16_bf16 v[184:199], v[212:215], a[244:247], v[184:199]
    global_load_dwordx4 v[56:59], v9, s[64:65] offset:2048 sc1
    global_load_dwordx4 v[60:63], v9, s[64:65] offset:3072 sc1
    ds_read_b64_tr_b16 v[212:213], v25 offset:27136
    ds_read_b64_tr_b16 v[214:215], v25 offset:28160
    s_waitcnt lgkmcnt(6)
    v_mfma_f32_32x32x16_bf16 v[168:183], v[200:203], a[248:251], v[168:183]
    global_load_dwordx4 v[64:67], v5, s[64:65] offset:-4096 sc1
    global_load_dwordx4 v[68:71], v5, s[64:65] offset:-3072 sc1
    ds_read_b64_tr_b16 v[200:201], v26 offset:0
    ds_read_b64_tr_b16 v[202:203], v26 offset:1024
    s_waitcnt lgkmcnt(6)
    v_mfma_f32_32x32x16_bf16 v[184:199], v[204:207], a[248:251], v[184:199]
    global_load_dwordx4 v[72:75], v5, s[64:65] offset:-2048 sc1
    global_load_dwordx4 v[76:79], v5, s[64:65] offset:-1024 sc1
    ds_read_b64_tr_b16 v[204:205], v27 offset:0
    ds_read_b64_tr_b16 v[206:207], v27 offset:1024
    s_waitcnt lgkmcnt(6)
    v_mfma_f32_32x32x16_bf16 v[168:183], v[208:211], a[252:255], v[168:183]
    global_load_dwordx4 v[80:83], v5, s[64:65] offset:0 sc1
    global_load_dwordx4 v[84:87], v5, s[64:65] offset:1024 sc1
    ds_read_b64_tr_b16 v[208:209], v26 offset:2048
    ds_read_b64_tr_b16 v[210:211], v26 offset:3072
    s_waitcnt lgkmcnt(6)
    v_mfma_f32_32x32x16_bf16 v[184:199], v[212:215], a[252:255], v[184:199]
    global_load_dwordx4 v[88:91], v5, s[64:65] offset:2048 sc1
    global_load_dwordx4 v[92:95], v5, s[64:65] offset:3072 sc1
    s_nop 1
    s_waitcnt vmcnt(14)
    v_max3_u32 v3, v32, v33, v34
    v_max3_u32 v2, v35, v36, v37
    v_max3_u32 v3, v3, v38, v39
    v_max_u32 v3, v3, v2
    v_cmp_eq_u32 vcc, -1, v3
    s_cbranch_vccnz L_f_r0
L_f_g0:
    ds_read_b64_tr_b16 v[212:213], v27 offset:2048
    ds_read_b64_tr_b16 v[214:215], v27 offset:3072
    s_waitcnt lgkmcnt(6)
    v_mfma_f32_32x32x16_bf16 v[96:111], v[200:203], v[32:35], v[168:183]
    ds_read_b64_tr_b16 v[200:201], v26 offset:3584
    ds_read_b64_tr_b16 v[202:203], v26 offset:4608
    s_waitcnt lgkmcnt(6)
    v_mfma_f32_32x32x16_bf16 v[112:127], v[204:207], v[32:35], v[184:199]
    ds_read_b64_tr_b16 v[204:205], v27 offset:3584
    ds_read_b64_tr_b16 v[206:207], v27 offset:4608
    s_waitcnt lgkmcnt(6)
    v_mfma_f32_32x32x16_bf16 v[96:111], v[208:211], v[36:39], v[96:111]
    s_waitcnt vmcnt(12)
    v_max3_u32 v3, v40, v41, v42
    v_max3_u32 v2, v43, v44, v45
    ds_read_b64_tr_b16 v[208:209], v26 offset:5632
    ds_read_b64_tr_b16 v[210:211], v26 offset:6656
    s_waitcnt lgkmcnt(6)
    v_mfma_f32_32x32x16_bf16 v[112:127], v[212:215], v[36:39], v[112:127]
    v_max3_u32 v3, v3, v46, v47
    v_max_u32 v3, v3, v2
    v_cmp_eq_u32 vcc, -1, v3
    s_cbranch_vccnz L_f_r1
L_f_g1:
    ds_read_b64_tr_b16 v[212:213], v27 offset:5632
    ds_read_b64_tr_b16 v[214:215], v27 offset:6656
    s_waitcnt lgkmcnt(6)
    v_mfma_f32_32x32x16_bf16 v[96:111], v[200:203], v[40:43], v[96:111]
    ds_read_b64_tr_b16 v[200:201], v26 offset:7168
    ds_read_b64_tr_b16 v[202:203], v26 offset:8192
    s_waitcnt lgkmcnt(6)
    v_mfma_f32_32x32x16_bf16 v[112:127], v[204:207], v[40:43], v[112:127]
    ds_read_b64_tr_b16 v[204:205], v27 offset:7168
    ds_read_b64_tr_b16 v[206:207], v27 offset:8192
    s_waitcnt lgkmcnt(6)
    v_mfma_f32_32x32x16_bf16 v[96:111], v[208:211], v[44:47], v[96:111]
    s_waitcnt vmcnt(10)
    v_max3_u32 v3, v48, v49, v50
    v_max3_u32 v2, v51, v52, v53
    ds_read_b64_tr_b16 v[208:209], v26 offset:9216
    ds_read_b64_tr_b16 v[210:211], v26 offset:10240
    s_waitcnt lgkmcnt(6)
    v_mfma_f32_32x32x16_bf16 v[112:127], v[212:215], v[44:47], v[112:127]
    v_max3_u32 v3, v3, v54, v55
    v_max_u32 v3, v3, v2
    v_cmp_eq_u32 vcc, -1, v3
    s_cbranch_vccnz L_f_r2
L_f_g2:
    ds_read_b64_tr_b16 v[212:213], v27 offset:9216
    ds_read_b64_tr_b16 v[214:215], v27 offset:10240
    s_waitcnt lgkmcnt(6)
    v_mfma_f32_32x32x16_bf16 v[96:111], v[200:203], v[48:51], v[96:111]
    ds_read_b64_tr_b16 v[200:201], v26 offset:10752
    ds_read_b64_tr_b16 v[202:203], v26 offset:11776
    s_waitcnt lgkmcnt(6)
    v_mfma_f32_32x32x16_bf16 v[112:127], v[204:207], v[48:51], v[112:127]
    ds_read_b64_tr_b16 v[204:205], v27 offset:10752
    ds_read_b64_tr_b16 v[206:207], v27 offset:11776
    s_waitcnt lgkmcnt(6)
    v_mfma_f32_32x32x16_bf16 v[96:111], v[208:211], v[52:55], v[96:111]
    s_waitcnt vmcnt(8)
    v_max3_u32 v3, v56, v57, v58
    v_max3_u32 v2, v59, v60, v61
    ds_read_b64_tr_b16 v[208:209], v26 offset:12800
    ds_read_b64_tr_b16 v[210:211], v26 offset:13824
    s_waitcnt lgkmcnt(6)
    v_mfma_f32_32x32x16_bf16 v[112:127], v[212:215], v[52:55], v[112:127]
    v_max3_u32 v3, v3, v62, v63
    v_max_u32 v3, v3, v2
    v_cmp_eq_u32 vcc, -1, v3
    s_cbranch_vccnz L_f_r3
L_f_g3:
    ds_read_b64_tr_b16 v[212:213], v27 offset:12800
    ds_read_b64_tr_b16 v[214:215], v27 offset:13824
    s_waitcnt lgkmcnt(6)
    v_mfma_f32_32x32x16_bf16 v[96:111], v[200:203], v[56:59], v[96:111]
    ds_read_b64_tr_b16 v[200:201], v26 offset:14336
    ds_read_b64_tr_b16 v[202:203], v26 offset:15360
    s_waitcnt lgkmcnt(6)
    v_mfma_f32_32x32x16_bf16 v[112:127], v[204:207], v[56:59], v[112:127]
    ds_read_b64_tr_b16 v[204:205], v27 offset:14336
    ds_read_b64_tr_b16 v[206:207], v27 offset:15360
    s_waitcnt lgkmcnt(6)
    v_mfma_f32_32x32x16_bf16 v[96:111], v[208:211], v[60:63], v[96:111]
    s_waitcnt vmcnt(6)
    v_max3_u32 v3, v64, v65, v66
    v_max3_u32 v2, v67, v68, v69
    ds_read_b64_tr_b16 v[208:209], v26 offset:16384
    ds_read_b64_tr_b16 v[210:211], v26 offset:17408
    s_waitcnt lgkmcnt(6)
    v_mfma_f32_32x32x16_bf16 v[112:127], v[212:215], v[60:63], v[112:127]
    v_max3_u32 v3, v3, v70, v71
    v_max_u32 v3, v3, v2
    v_cmp_eq_u32 vcc, -1, v3
    s_cbranch_vccnz L_f_r4
L_f_g4:
    ds_read_b64_tr_b16 v[212:213], v27 offset:16384
    ds_read_b64_tr_b16 v[214:215], v27 offset:17408
    s_waitcnt lgkmcnt(6)
    v_mfma_f32_32x32x16_bf16 v[96:111], v[200:203], v[64:67], v[96:111]
    ds_read_b64_tr_b16 v[200:201], v26 offset:17920
    ds_read_b64_tr_b16 v[202:203], v26 offset:18944
    s_waitcnt lgkmcnt(6)
    v_mfma_f32_32x32x16_bf16 v[112:127], v[204:207], v[64:67], v[112:127]
    ds_read_b64_tr_b16 v[204:205], v27 offset:17920
    ds_read_b64_tr_b16 v[206:207], v27 offset:18944
    s_waitcnt lgkmcnt(6)
    v_mfma_f32_32x32x16_bf16 v[96:111], v[208:211], v[68:71], v[96:111]
    s_waitcnt vmcnt(4)
    v_max3_u32 v3, v72, v73, v74
    v_max3_u32 v2, v75, v76, v77
    ds_read_b64_tr_b16 v[208:209], v26 offset:19968
    ds_read_b64_tr_b16 v[210:211], v26 offset:20992
    s_waitcnt lgkmcnt(6)
    v_mfma_f32_32x32x16_bf16 v[112:127], v[212:215], v[68:71], v[112:127]
    v_max3_u32 v3, v3, v78, v79
    v_max_u32 v3, v3, v2
    v_cmp_eq_u32 vcc, -1, v3
    s_cbranch_vccnz L_f_r5
L_f_g5:
    ds_read_b64_tr_b16 v[212:213], v27 offset:19968
    ds_read_b64_tr_b16 v[214:215], v27 offset:20992
    s_waitcnt lgkmcnt(6)
    v_mfma_f32_32x32x16_bf16 v[96:111], v[200:203], v[72:75], v[96:111]
    ds_read_b64_tr_b16 v[200:201], v26 offset:21504
    ds_read_b64_tr_b16 v[202:203], v26 offset:22528
    s_waitcnt lgkmcnt(6)
    v_mfma_f32_32x32x16_bf16 v[112:127], v[204:207], v[72:75], v[112:127]
    ds_read_b64_tr_b16 v[204:205], v27 offset:21504
    ds_read_b64_tr_b16 v[206:207], v27 offset:22528
    s_waitcnt lgkmcnt(6)
    v_mfma_f32_32x32x16_bf16 v[96:111], v[208:211], v[76:79], v[96:111]
    s_waitcnt vmcnt(2)
    v_max3_u32 v3, v80, v81, v82
    v_max3_u32 v2, v83, v84, v85
    ds_read_b64_tr_b16 v[208:209], v26 offset:23552
    ds_read_b64_tr_b16 v[210:211], v26 offset:24576
    s_waitcnt lgkmcnt(6)
    v_mfma_f32_32x32x16_bf16 v[112:127], v[212:215], v[76:79], v[112:127]
    v_max3_u32 v3, v3, v86, v87
    v_max_u32 v3, v3, v2
    v_cmp_eq_u32 vcc, -1, v3
    s_cbranch_vccnz L_f_r6
L_f_g6:
    ds_read_b64_tr_b16 v[212:213], v27 offset:23552
    ds_read_b64_tr_b16 v[214:215], v27 offset:24576
    s_waitcnt lgkmcnt(6)
    v_mfma_f32_32x32x16_bf16 v[96:111], v[200:203], v[80:83], v[96:111]
    ds_read_b64_tr_b16 v[200:201], v26 offset:25088
L_f_pad13:
    s_cbranch_execz L_f_tdone
    ds_read_b64_tr_b16 v[202:203], v26 offset:26112
    s_waitcnt lgkmcnt(6)
    v_mfma_f32_32x32x16_bf16 v[112:127], v[204:207], v[80:83], v[112:127]
    ds_read_b64_tr_b16 v[204:205], v27 offset:25088
    ds_read_b64_tr_b16 v[206:207], v27 offset:26112
    s_waitcnt lgkmcnt(6)
    v_mfma_f32_32x32x16_bf16 v[96:111], v[208:211], v[84:87], v[96:111]
    s_waitcnt vmcnt(0)
    v_max3_u32 v3, v88, v89, v90
    v_max3_u32 v2, v91, v92, v93
    ds_read_b64_tr_b16 v[208:209], v26 offset:27136
    ds_read_b64_tr_b16 v[210:211], v28 offset:28160
    s_waitcnt lgkmcnt(6)
    v_mfma_f32_32x32x16_bf16 v[112:127], v[212:215], v[84:87], v[112:127]
    v_max3_u32 v3, v3, v94, v95
    v_max_u32 v3, v3, v2
    v_cmp_eq_u32 vcc, -1, v3
    s_cbranch_vccnz L_f_r7
L_f_g7:
    ds_read_b64_tr_b16 v[212:213], v27 offset:27136
    ds_read_b64_tr_b16 v[214:215], v29 offset:28160
    s_waitcnt lgkmcnt(6)
    v_mfma_f32_32x32x16_bf16 v[96:111], v[200:203], v[88:91], v[96:111]
    s_waitcnt lgkmcnt(4)
    v_mfma_f32_32x32x16_bf16 v[112:127], v[204:207], v[88:91], v[112:127]
    s_waitcnt lgkmcnt(2)
    v_mfma_f32_32x32x16_bf16 v[96:111], v[208:211], v[92:95], v[96:111]
    s_waitcnt lgkmcnt(0)
    v_mfma_f32_32x32x16_bf16 v[112:127], v[212:215], v[92:95], v[112:127]
L_f_store:
    s_xor_b32 s40, s36, 2
    s_mul_i32 s40, s40, 12288
    v_add_u32 v4, s40, v6
    s_nop 8
    ds_write_b128 v12, v[112:115] offset:4096
    ds_write_b128 v12, v[116:119] offset:5120
    ds_write_b128 v12, v[120:123] offset:6144
    ds_write_b128 v12, v[124:127] offset:7168
    s_waitcnt lgkmcnt(0)
    s_barrier
    ds_read_b128 v[168:171], v4 offset:4096
    ds_read_b128 v[172:175], v4 offset:5120
    ds_read_b128 v[176:179], v4 offset:6144
    ds_read_b128 v[180:183], v4 offset:7168
    s_waitcnt lgkmcnt(3)
    v_pk_add_f32 v[96:97], v[96:97], v[168:169]
    v_pk_add_f32 v[98:99], v[98:99], v[170:171]
    v_cvt_pk_bf16_f32 v240, v96, v97
    v_cvt_pk_bf16_f32 v241, v98, v99
    s_waitcnt lgkmcnt(2)
    v_pk_add_f32 v[100:101], v[100:101], v[172:173]
    v_pk_add_f32 v[102:103], v[102:103], v[174:175]
    v_cvt_pk_bf16_f32 v242, v100, v101
    v_cvt_pk_bf16_f32 v243, v102, v103
    s_nop 1
    v_permlane32_swap_b32 v240, v242
    v_permlane32_swap_b32 v241, v243
    buffer_store_dwordx4 v[240:243], v19, s[20:23], s59 offen offset:0
    s_waitcnt lgkmcnt(1)
    v_pk_add_f32 v[104:105], v[104:105], v[176:177]
    v_pk_add_f32 v[106:107], v[106:107], v[178:179]
    v_cvt_pk_bf16_f32 v244, v104, v105
    v_cvt_pk_bf16_f32 v245, v106, v107
    s_waitcnt lgkmcnt(0)
    v_pk_add_f32 v[108:109], v[108:109], v[180:181]
    v_pk_add_f32 v[110:111], v[110:111], v[182:183]
    v_cvt_pk_bf16_f32 v246, v108, v109
    v_cvt_pk_bf16_f32 v247, v110, v111
    s_nop 1
    v_permlane32_swap_b32 v244, v246
    v_permlane32_swap_b32 v245, v247
    buffer_store_dwordx4 v[244:247], v19, s[20:23], s59 offen offset:32
    s_or_b32 s40, s2, s36
    s_cmp_lg_u32 s40, 0
    s_cbranch_scc1 L_f_exit
    v_mov_b32 v4, 0x90c000
    v_mov_b32 v3, s67
    s_mov_b64 exec, 1
    buffer_store_dword v3, v4, s[16:19], 0 offen sc1
    s_mov_b64 exec, -1
L_f_exit:
L_f_end:
    s_endpgm
L_f_r0:
    s_add_u32 s49, s49, 1
    s_cmp_gt_u32 s49, 262144
    s_cbranch_scc1 L_f_g0
    global_load_dwordx4 v[32:35], v9, s[64:65] offset:-4096 sc1
    global_load_dwordx4 v[36:39], v9, s[64:65] offset:-3072 sc1
    global_load_dwordx4 v[40:43], v9, s[64:65] offset:-2048 sc1
    global_load_dwordx4 v[44:47], v9, s[64:65] offset:-1024 sc1
    global_load_dwordx4 v[48:51], v9, s[64:65] offset:0 sc1
    global_load_dwordx4 v[52:55], v9, s[64:65] offset:1024 sc1
    global_load_dwordx4 v[56:59], v9, s[64:65] offset:2048 sc1
    global_load_dwordx4 v[60:63], v9, s[64:65] offset:3072 sc1
    global_load_dwordx4 v[64:67], v5, s[64:65] offset:-4096 sc1
    global_load_dwordx4 v[68:71], v5, s[64:65] offset:-3072 sc1
    global_load_dwordx4 v[72:75], v5, s[64:65] offset:-2048 sc1
    global_load_dwordx4 v[76:79], v5, s[64:65] offset:-1024 sc1
    global_load_dwordx4 v[80:83], v5, s[64:65] offset:0 sc1
    global_load_dwordx4 v[84:87], v5, s[64:65] offset:1024 sc1
    global_load_dwordx4 v[88:91], v5, s[64:65] offset:2048 sc1
    global_load_dwordx4 v[92:95], v5, s[64:65] offset:3072 sc1
    s_waitcnt vmcnt(14)
    v_max3_u32 v3, v32, v33, v34
    v_max3_u32 v2, v35, v36, v37
    v_max3_u32 v3, v3, v38, v39
    v_max_u32 v3, v3, v2
    v_cmp_eq_u32 vcc, -1, v3
    s_cbranch_vccnz L_f_r0
    s_branch L_f_g0
L_f_r1:
    s_add_u32 s49, s49, 1
    s_cmp_gt_u32 s49, 262144
    s_cbranch_scc1 L_f_g1
    global_load_dwordx4 v[40:43], v9, s[64:65] offset:-2048 sc1
    global_load_dwordx4 v[44:47], v9, s[64:65] offset:-1024 sc1
    global_load_dwordx4 v[48:51], v9, s[64:65] offset:0 sc1
    global_load_dwordx4 v[52:55], v9, s[64:65] offset:1024 sc1
    global_load_dwordx4 v[56:59], v9, s[64:65] offset:2048 sc1
    global_load_dwordx4 v[60:63], v9, s[64:65] offset:3072 sc1
    global_load_dwordx4 v[64:67], v5, s[64:65] offset:-4096 sc1
    global_load_dwordx4 v[68:71], v5, s[64:65] offset:-3072 sc1
    global_load_dwordx4 v[72:75], v5, s[64:65] offset:-2048 sc1
    global_load_dwordx4 v[76:79], v5, s[64:65] offset:-1024 sc1
    global_load_dwordx4 v[80:83], v5, s[64:65] offset:0 sc1
    global_load_dwordx4 v[84:87], v5, s[64:65] offset:1024 sc1
    global_load_dwordx4 v[88:91], v5, s[64:65] offset:2048 sc1
    global_load_dwordx4 v[92:95], v5, s[64:65] offset:3072 sc1
    s_waitcnt vmcnt(12)
    v_max3_u32 v3, v40, v41, v42
    v_max3_u32 v2, v43, v44, v45
    v_max3_u32 v3, v3, v46, v47
    v_max_u32 v3, v3, v2
    v_cmp_eq_u32 vcc, -1, v3
    s_cbranch_vccnz L_f_r1
    s_branch L_f_g1
L_f_r2:
    s_add_u32 s49, s49, 1
    s_cmp_gt_u32 s49, 262144
    s_cbranch_scc1 L_f_g2
    global_load_dwordx4 v[48:51], v9, s[64:65] offset:0 sc1
    global_load_dwordx4 v[52:55], v9, s[64:65] offset:1024 sc1
    global_load_dwordx4 v[56:59], v9, s[64:65] offset:2048 sc1
    global_load_dwordx4 v[60:63], v9, s[64:65] offset:3072 sc1
    global_load_dwordx4 v[64:67], v5, s[64:65] offset:-4096 sc1
    global_load_dwordx4 v[68:71], v5, s[64:65] offset:-3072 sc1
    global_load_dwordx4 v[72:75], v5, s[64:65] offset:-2048 sc1
    global_load_dwordx4 v[76:79], v5, s[64:65] offset:-1024 sc1
    global_load_dwordx4 v[80:83], v5, s[64:65] offset:0 sc1
    global_load_dwordx4 v[84:87], v5, s[64:65] offset:1024 sc1
    global_load_dwordx4 v[88:91], v5, s[64:65] offset:2048 sc1
    global_load_dwordx4 v[92:95], v5, s[64:65] offset:3072 sc1
    s_waitcnt vmcnt(10)
    v_max3_u32 v3, v48, v49, v50
    v_max3_u32 v2, v51, v52, v53
    v_max3_u32 v3, v3, v54, v55
    v_max_u32 v3, v3, v2
    v_cmp_eq_u32 vcc, -1, v3
    s_cbranch_vccnz L_f_r2
    s_branch L_f_g2
L_f_r3:
    s_add_u32 s49, s49, 1
    s_cmp_gt_u32 s49, 262144
    s_cbranch_scc1 L_f_g3
    global_load_dwordx4 v[56:59], v9, s[64:65] offset:2048 sc1
    global_load_dwordx4 v[60:63], v9, s[64:65] offset:3072 sc1
    global_load_dwordx4 v[64:67], v5, s[64:65] offset:-4096 sc1
    global_load_dwordx4 v[68:71], v5, s[64:65] offset:-3072 sc1
    global_load_dwordx4 v[72:75], v5, s[64:65] offset:-2048 sc1
    global_load_dwordx4 v[76:79], v5, s[64:65] offset:-1024 sc1
    global_load_dwordx4 v[80:83], v5, s[64:65] offset:0 sc1
    global_load_dwordx4 v[84:87], v5, s[64:65] offset:1024 sc1
    global_load_dwordx4 v[88:91], v5, s[64:65] offset:2048 sc1
    global_load_dwordx4 v[92:95], v5, s[64:65] offset:3072 sc1
    s_waitcnt vmcnt(8)
    v_max3_u32 v3, v56, v57, v58
    v_max3_u32 v2, v59, v60, v61
    v_max3_u32 v3, v3, v62, v63
    v_max_u32 v3, v3, v2
    v_cmp_eq_u32 vcc, -1, v3
    s_cbranch_vccnz L_f_r3
    s_branch L_f_g3
L_f_r4:
    s_add_u32 s49, s49, 1
    s_cmp_gt_u32 s49, 262144
    s_cbranch_scc1 L_f_g4
    global_load_dwordx4 v[64:67], v5, s[64:65] offset:-4096 sc1
    global_load_dwordx4 v[68:71], v5, s[64:65] offset:-3072 sc1
    global_load_dwordx4 v[72:75], v5, s[64:65] offset:-2048 sc1
    global_load_dwordx4 v[76:79], v5, s[64:65] offset:-1024 sc1
    global_load_dwordx4 v[80:83], v5, s[64:65] offset:0 sc1
    global_load_dwordx4 v[84:87], v5, s[64:65] offset:1024 sc1
    global_load_dwordx4 v[88:91], v5, s[64:65] offset:2048 sc1
    global_load_dwordx4 v[92:95], v5, s[64:65] offset:3072 sc1
    s_waitcnt vmcnt(6)
    v_max3_u32 v3, v64, v65, v66
    v_max3_u32 v2, v67, v68, v69
    v_max3_u32 v3, v3, v70, v71
    v_max_u32 v3, v3, v2
    v_cmp_eq_u32 vcc, -1, v3
    s_cbranch_vccnz L_f_r4
    s_branch L_f_g4
L_f_r5:
    s_add_u32 s49, s49, 1
    s_cmp_gt_u32 s49, 262144
    s_cbranch_scc1 L_f_g5
    global_load_dwordx4 v[72:75], v5, s[64:65] offset:-2048 sc1
    global_load_dwordx4 v[76:79], v5, s[64:65] offset:-1024 sc1
    global_load_dwordx4 v[80:83], v5, s[64:65] offset:0 sc1
    global_load_dwordx4 v[84:87], v5, s[64:65] offset:1024 sc1
    global_load_dwordx4 v[88:91], v5, s[64:65] offset:2048 sc1
    global_load_dwordx4 v[92:95], v5, s[64:65] offset:3072 sc1
    s_waitcnt vmcnt(4)
    v_max3_u32 v3, v72, v73, v74
    v_max3_u32 v2, v75, v76, v77
    v_max3_u32 v3, v3, v78, v79
    v_max_u32 v3, v3, v2
    v_cmp_eq_u32 vcc, -1, v3
    s_cbranch_vccnz L_f_r5
    s_branch L_f_g5
L_f_r6:
    s_add_u32 s49, s49, 1
    s_cmp_gt_u32 s49, 262144
    s_cbranch_scc1 L_f_g6
    global_load_dwordx4 v[80:83], v5, s[64:65] offset:0 sc1
    global_load_dwordx4 v[84:87], v5, s[64:65] offset:1024 sc1
    global_load_dwordx4 v[88:91], v5, s[64:65] offset:2048 sc1
    global_load_dwordx4 v[92:95], v5, s[64:65] offset:3072 sc1
    s_waitcnt vmcnt(2)
    v_max3_u32 v3, v80, v81, v82
    v_max3_u32 v2, v83, v84, v85
    v_max3_u32 v3, v3, v86, v87
    v_max_u32 v3, v3, v2
    v_cmp_eq_u32 vcc, -1, v3
    s_cbranch_vccnz L_f_r6
    s_branch L_f_g6
L_f_r7:
    s_add_u32 s49, s49, 1
    s_cmp_gt_u32 s49, 262144
    s_cbranch_scc1 L_f_g7
    global_load_dwordx4 v[88:91], v5, s[64:65] offset:2048 sc1
    global_load_dwordx4 v[92:95], v5, s[64:65] offset:3072 sc1
    s_waitcnt vmcnt(0)
    v_max3_u32 v3, v88, v89, v90
    v_max3_u32 v2, v91, v92, v93
    v_max3_u32 v3, v3, v94, v95
    v_max_u32 v3, v3, v2
    v_cmp_eq_u32 vcc, -1, v3
    s_cbranch_vccnz L_f_r7
    s_branch L_f_g7
L_f_fb:
    v_mov_b32 v236, 0xff800000
    v_mov_b32 v237, 0xff800000
    v_mov_b32 v238, 0xff800000
    v_mov_b32 v239, 0xff800000
    v_subrev_u32 v7, 61440, v7
    s_mov_b32 s43, 0
L_f_fbmax:
    buffer_load_dwordx4 a[0:3], v7, s[16:19], s43 offen offset:0 sc1
    buffer_load_dwordx4 a[4:7], v7, s[16:19], s43 offen offset:1024 sc1
    s_waitcnt vmcnt(0)
    v_mfma_f32_32x32x16_bf16 v[64:79], a[0:3], v[32:35], 0
    v_mfma_f32_32x32x16_bf16 v[64:79], a[4:7], v[36:39], v[64:79]
    s_nop 11
    v_max3_f32 v236, v236, v64, v65
    v_max3_f32 v236, v236, v66, v67
    v_max3_f32 v236, v236, v68, v69
    v_max3_f32 v236, v236, v70, v71
    v_max3_f32 v236, v236, v72, v73
    v_max3_f32 v236, v236, v74, v75
    v_max3_f32 v236, v236, v76, v77
    v_max3_f32 v236, v236, v78, v79
    v_mfma_f32_32x32x16_bf16 v[64:79], a[0:3], v[40:43], 0
    v_mfma_f32_32x32x16_bf16 v[64:79], a[4:7], v[44:47], v[64:79]
    s_nop 11
    v_max3_f32 v237, v237, v64, v65
    v_max3_f32 v237, v237, v66, v67
    v_max3_f32 v237, v237, v68, v69
    v_max3_f32 v237, v237, v70, v71
    v_max3_f32 v237, v237, v72, v73
    v_max3_f32 v237, v237, v74, v75
    v_max3_f32 v237, v237, v76, v77
    v_max3_f32 v237, v237, v78, v79
    v_mfma_f32_32x32x16_bf16 v[64:79], a[0:3], v[48:51], 0
    v_mfma_f32_32x32x16_bf16 v[64:79], a[4:7], v[52:55], v[64:79]
    s_nop 11
    v_max3_f32 v238, v238, v64, v65
    v_max3_f32 v238, v238, v66, v67
    v_max3_f32 v238, v238, v68, v69
    v_max3_f32 v238, v238, v70, v71
    v_max3_f32 v238, v238, v72, v73
    v_max3_f32 v238, v238, v74, v75
    v_max3_f32 v238, v238, v76, v77
    v_max3_f32 v238, v238, v78, v79
    v_mfma_f32_32x32x16_bf16 v[64:79], a[0:3], v[56:59], 0
    v_mfma_f32_32x32x16_bf16 v[64:79], a[4:7], v[60:63], v[64:79]
    s_nop 11
    v_max3_f32 v239, v239, v64, v65
    v_max3_f32 v239, v239, v66, v67
    v_max3_f32 v239, v239, v68, v69
    v_max3_f32 v239, v239, v70, v71
    v_max3_f32 v239, v239, v72, v73
    v_max3_f32 v239, v239, v74, v75
    v_max3_f32 v239, v239, v76, v77
    v_max3_f32 v239, v239, v78, v79
    s_add_u32 s43, s43, 4096
    s_cmp_lt_u32 s43, 0x10000
    s_cbranch_scc1 L_f_fbmax
    s_add_u32 s40, s36, 1
    s_and_b32 s40, s40, 3
    s_lshl_b32 s40, s40, 2
    s_add_u32 s40, s40, s36
    s_lshl_b32 s40, s40, 8
    v_lshl_add_u32 v2, v1, 2, s40
    ds_write_b32 v2, v236 offset:8192
    s_add_u32 s40, s36, 2
    s_and_b32 s40, s40, 3
    s_lshl_b32 s40, s40, 2
    s_add_u32 s40, s40, s36
    s_lshl_b32 s40, s40, 8
    v_lshl_add_u32 v2, v1, 2, s40
    ds_write_b32 v2, v237 offset:8192
    s_add_u32 s40, s36, 3
    s_and_b32 s40, s40, 3
    s_lshl_b32 s40, s40, 2
    s_add_u32 s40, s40, s36
    s_lshl_b32 s40, s40, 8
    v_lshl_add_u32 v2, v1, 2, s40
    ds_write_b32 v2, v238 offset:8192
    s_add_u32 s40, s36, 4
    s_and_b32 s40, s40, 3
    s_lshl_b32 s40, s40, 2
    s_add_u32 s40, s40, s36
    s_lshl_b32 s40, s40, 8
    v_lshl_add_u32 v2, v1, 2, s40
    ds_write_b32 v2, v239 offset:8192
    s_waitcnt lgkmcnt(0)
    s_barrier
    v_and_b32 v4, 31, v1
    s_add_u32 s40, s36, 1
    s_and_b32 s40, s40, 3
    s_lshl_b32 s40, s40, 10
    v_lshl_add_u32 v2, v4, 2, s40
    ds_read_b32 v64, v2 offset:8192
    ds_read_b32 v65, v2 offset:8320
    ds_read_b32 v66, v2 offset:8448
    ds_read_b32 v67, v2 offset:8576
    ds_read_b32 v68, v2 offset:8704
    ds_read_b32 v69, v2 offset:8832
    ds_read_b32 v70, v2 offset:8960
    ds_read_b32 v71, v2 offset:9088
    s_waitcnt lgkmcnt(0)
    v_max3_f32 v3, v64, v65, v66
    v_max3_f32 v3, v3, v67, v68
    v_max3_f32 v3, v3, v69, v70
    v_max_f32 v3, v3, v71
    v_sub_f32 v3, 0, v3
    v_cvt_pk_bf16_f32 v5, v3, v3
    v_and_b32 v30, 0xffff0000, v5
    v_sub_f32 v3, v3, v30
    v_cvt_pk_bf16_f32 v5, v3, v3
    v_and_b32 v31, 0xffff0000, v5
    v_sub_f32 v3, v3, v31
    s_mov_b32 exec_lo, 0
    v_cvt_pk_bf16_f32 v38, v30, v31
    v_cvt_pk_bf16_f32 v39, v3, 0
    s_mov_b32 exec_lo, -1
    s_add_u32 s40, s36, 2
    s_and_b32 s40, s40, 3
    s_lshl_b32 s40, s40, 10
    v_lshl_add_u32 v2, v4, 2, s40
    ds_read_b32 v64, v2 offset:8192
    ds_read_b32 v65, v2 offset:8320
    ds_read_b32 v66, v2 offset:8448
    ds_read_b32 v67, v2 offset:8576
    ds_read_b32 v68, v2 offset:8704
    ds_read_b32 v69, v2 offset:8832
    ds_read_b32 v70, v2 offset:8960
    ds_read_b32 v71, v2 offset:9088
    s_waitcnt lgkmcnt(0)
    v_max3_f32 v3, v64, v65, v66
    v_max3_f32 v3, v3, v67, v68
    v_max3_f32 v3, v3, v69, v70
    v_max_f32 v3, v3, v71
    v_sub_f32 v3, 0, v3
    v_cvt_pk_bf16_f32 v5, v3, v3
    v_and_b32 v30, 0xffff0000, v5
    v_sub_f32 v3, v3, v30
    v_cvt_pk_bf16_f32 v5, v3, v3
    v_and_b32 v31, 0xffff0000, v5
    v_sub_f32 v3, v3, v31
    s_mov_b32 exec_lo, 0
    v_cvt_pk_bf16_f32 v46, v30, v31
    v_cvt_pk_bf16_f32 v47, v3, 0
    s_mov_b32 exec_lo, -1
    s_add_u32 s40, s36, 3
    s_and_b32 s40, s40, 3
    s_lshl_b32 s40, s40, 10
    v_lshl_add_u32 v2, v4, 2, s40
    ds_read_b32 v64, v2 offset:8192
    ds_read_b32 v65, v2 offset:8320
    ds_read_b32 v66, v2 offset:8448
    ds_read_b32 v67, v2 offset:8576
    ds_read_b32 v68, v2 offset:8704
    ds_read_b32 v69, v2 offset:8832
    ds_read_b32 v70, v2 offset:8960
    ds_read_b32 v71, v2 offset:9088
    s_waitcnt lgkmcnt(0)
    v_max3_f32 v3, v64, v65, v66
    v_max3_f32 v3, v3, v67, v68
    v_max3_f32 v3, v3, v69, v70
    v_max_f32 v3, v3, v71
    v_sub_f32 v3, 0, v3
    v_cvt_pk_bf16_f32 v5, v3, v3
    v_and_b32 v30, 0xffff0000, v5
    v_sub_f32 v3, v3, v30
    v_cvt_pk_bf16_f32 v5, v3, v3
    v_and_b32 v31, 0xffff0000, v5
    v_sub_f32 v3, v3, v31
    s_mov_b32 exec_lo, 0
    v_cvt_pk_bf16_f32 v54, v30, v31
    v_cvt_pk_bf16_f32 v55, v3, 0
    s_mov_b32 exec_lo, -1
    s_add_u32 s40, s36, 4
    s_and_b32 s40, s40, 3
    s_lshl_b32 s40, s40, 10
    v_lshl_add_u32 v2, v4, 2, s40
    ds_read_b32 v64, v2 offset:8192
    ds_read_b32 v65, v2 offset:8320
    ds_read_b32 v66, v2 offset:8448
    ds_read_b32 v67, v2 offset:8576
    ds_read_b32 v68, v2 offset:8704
    ds_read_b32 v69, v2 offset:8832
    ds_read_b32 v70, v2 offset:8960
    ds_read_b32 v71, v2 offset:9088
    s_waitcnt lgkmcnt(0)
    v_max3_f32 v3, v64, v65, v66
    v_max3_f32 v3, v3, v67, v68
    v_max3_f32 v3, v3, v69, v70
    v_max_f32 v3, v3, v71
    v_sub_f32 v3, 0, v3
    v_cvt_pk_bf16_f32 v5, v3, v3
    v_and_b32 v30, 0xffff0000, v5
    v_sub_f32 v3, v3, v30
    v_cvt_pk_bf16_f32 v5, v3, v3
    v_and_b32 v31, 0xffff0000, v5
    v_sub_f32 v3, v3, v31
    s_mov_b32 exec_lo, 0
    v_cvt_pk_bf16_f32 v62, v30, v31
    v_cvt_pk_bf16_f32 v63, v3, 0
    s_mov_b32 exec_lo, -1
    v_mov_b32 v104, 0
    v_mov_b32 v105, 0
    v_mov_b32 v106, 0
    v_mov_b32 v107, 0
    v_mov_b32 v108, 0
    v_mov_b32 v109, 0
    v_mov_b32 v110, 0
    v_mov_b32 v111, 0
    v_mov_b32 v112, 0
    v_mov_b32 v113, 0
    v_mov_b32 v114, 0
    v_mov_b32 v115, 0
    v_mov_b32 v116, 0
    v_mov_b32 v117, 0
    v_mov_b32 v118, 0
    v_mov_b32 v119, 0
    v_mov_b32 v120, 0
    v_mov_b32 v121, 0
    v_mov_b32 v122, 0
    v_mov_b32 v123, 0
    v_mov_b32 v124, 0
    v_mov_b32 v125, 0
    v_mov_b32 v126, 0
    v_mov_b32 v127, 0
    v_mov_b32 v128, 0
    v_mov_b32 v129, 0
    v_mov_b32 v130, 0
    v_mov_b32 v131, 0
    v_mov_b32 v132, 0
    v_mov_b32 v133, 0
    v_mov_b32 v134, 0
    v_mov_b32 v135, 0
    v_mov_b32 v136, 0
    v_mov_b32 v137, 0
    v_mov_b32 v138, 0
    v_mov_b32 v139, 0
    v_mov_b32 v140, 0
    v_mov_b32 v141, 0
    v_mov_b32 v142, 0
    v_mov_b32 v143, 0
    v_mov_b32 v144, 0
    v_mov_b32 v145, 0
    v_mov_b32 v146, 0
    v_mov_b32 v147, 0
    v_mov_b32 v148, 0
    v_mov_b32 v149, 0
    v_mov_b32 v150, 0
    v_mov_b32 v151, 0
    v_mov_b32 v152, 0
    v_mov_b32 v153, 0
    v_mov_b32 v154, 0
    v_mov_b32 v155, 0
    v_mov_b32 v156, 0
    v_mov_b32 v157, 0
    v_mov_b32 v158, 0
    v_mov_b32 v159, 0
    v_mov_b32 v160, 0
    v_mov_b32 v161, 0
    v_mov_b32 v162, 0
    v_mov_b32 v163, 0
    v_mov_b32 v164, 0
    v_mov_b32 v165, 0
    v_mov_b32 v166, 0
    v_mov_b32 v167, 0
    s_barrier
    s_mov_b32 s43, 0
L_f_fbpv:
    buffer_load_dwordx4 a[0:3], v7, s[16:19], s43 offen offset:0 sc1
    buffer_load_dwordx4 a[4:7], v7, s[16:19], s43 offen offset:1024 sc1
    buffer_load_dwordx4 a[8:11], v7, s[16:19], s43 offen offset:2048 sc1
    buffer_load_dwordx4 a[12:15], v7, s[16:19], s43 offen offset:3072 sc1
    s_waitcnt vmcnt(0)
    v_mfma_f32_32x32x16_bf16 v[64:79], a[0:3], v[32:35], 0
    v_mfma_f32_32x32x16_bf16 v[64:79], a[4:7], v[36:39], v[64:79]
    s_nop 11
    v_exp_f32 v64, v64
    v_exp_f32 v65, v65
    v_exp_f32 v66, v66
    v_exp_f32 v67, v67
    v_exp_f32 v68, v68
    v_exp_f32 v69, v69
    v_exp_f32 v70, v70
    v_exp_f32 v71, v71
    v_exp_f32 v72, v72
    v_exp_f32 v73, v73
    v_exp_f32 v74, v74
    v_exp_f32 v75, v75
    v_exp_f32 v76, v76
    v_exp_f32 v77, v77
    v_exp_f32 v78, v78
    v_exp_f32 v79, v79
    s_nop 0
    v_cvt_pk_bf16_f32 v96, v64, v65
    v_cvt_pk_bf16_f32 v97, v66, v67
    v_cvt_pk_bf16_f32 v98, v68, v69
    v_cvt_pk_bf16_f32 v99, v70, v71
    v_cvt_pk_bf16_f32 v100, v72, v73
    v_cvt_pk_bf16_f32 v101, v74, v75
    v_cvt_pk_bf16_f32 v102, v76, v77
    v_cvt_pk_bf16_f32 v103, v78, v79
    s_nop 1
    v_mfma_f32_32x32x16_bf16 v[104:119], a[8:11], v[96:99], v[104:119]
    v_mfma_f32_32x32x16_bf16 v[104:119], a[12:15], v[100:103], v[104:119]
    v_mfma_f32_32x32x16_bf16 v[64:79], a[0:3], v[40:43], 0
    v_mfma_f32_32x32x16_bf16 v[64:79], a[4:7], v[44:47], v[64:79]
    s_nop 11
    v_exp_f32 v64, v64
    v_exp_f32 v65, v65
    v_exp_f32 v66, v66
    v_exp_f32 v67, v67
    v_exp_f32 v68, v68
    v_exp_f32 v69, v69
    v_exp_f32 v70, v70
    v_exp_f32 v71, v71
    v_exp_f32 v72, v72
    v_exp_f32 v73, v73
    v_exp_f32 v74, v74
    v_exp_f32 v75, v75
    v_exp_f32 v76, v76
    v_exp_f32 v77, v77
    v_exp_f32 v78, v78
    v_exp_f32 v79, v79
    s_nop 0
    v_cvt_pk_bf16_f32 v96, v64, v65
    v_cvt_pk_bf16_f32 v97, v66, v67
    v_cvt_pk_bf16_f32 v98, v68, v69
    v_cvt_pk_bf16_f32 v99, v70, v71
    v_cvt_pk_bf16_f32 v100, v72, v73
    v_cvt_pk_bf16_f32 v101, v74, v75
    v_cvt_pk_bf16_f32 v102, v76, v77
    v_cvt_pk_bf16_f32 v103, v78, v79
    s_nop 1
    v_mfma_f32_32x32x16_bf16 v[120:135], a[8:11], v[96:99], v[120:135]
    v_mfma_f32_32x32x16_bf16 v[120:135], a[12:15], v[100:103], v[120:135]
    v_mfma_f32_32x32x16_bf16 v[64:79], a[0:3], v[48:51], 0
    v_mfma_f32_32x32x16_bf16 v[64:79], a[4:7], v[52:55], v[64:79]
    s_nop 11
    v_exp_f32 v64, v64
    v_exp_f32 v65, v65
    v_exp_f32 v66, v66
    v_exp_f32 v67, v67
    v_exp_f32 v68, v68
    v_exp_f32 v69, v69
    v_exp_f32 v70, v70
    v_exp_f32 v71, v71
    v_exp_f32 v72, v72
    v_exp_f32 v73, v73
    v_exp_f32 v74, v74
    v_exp_f32 v75, v75
    v_exp_f32 v76, v76
    v_exp_f32 v77, v77
    v_exp_f32 v78, v78
    v_exp_f32 v79, v79
    s_nop 0
    v_cvt_pk_bf16_f32 v96, v64, v65
    v_cvt_pk_bf16_f32 v97, v66, v67
    v_cvt_pk_bf16_f32 v98, v68, v69
    v_cvt_pk_bf16_f32 v99, v70, v71
    v_cvt_pk_bf16_f32 v100, v72, v73
    v_cvt_pk_bf16_f32 v101, v74, v75
    v_cvt_pk_bf16_f32 v102, v76, v77
    v_cvt_pk_bf16_f32 v103, v78, v79
    s_nop 1
    v_mfma_f32_32x32x16_bf16 v[136:151], a[8:11], v[96:99], v[136:151]
    v_mfma_f32_32x32x16_bf16 v[136:151], a[12:15], v[100:103], v[136:151]
    v_mfma_f32_32x32x16_bf16 v[64:79], a[0:3], v[56:59], 0
    v_mfma_f32_32x32x16_bf16 v[64:79], a[4:7], v[60:63], v[64:79]
    s_nop 11
    v_exp_f32 v64, v64
    v_exp_f32 v65, v65
    v_exp_f32 v66, v66
    v_exp_f32 v67, v67
    v_exp_f32 v68, v68
    v_exp_f32 v69, v69
    v_exp_f32 v70, v70
    v_exp_f32 v71, v71
    v_exp_f32 v72, v72
    v_exp_f32 v73, v73
    v_exp_f32 v74, v74
    v_exp_f32 v75, v75
    v_exp_f32 v76, v76
    v_exp_f32 v77, v77
    v_exp_f32 v78, v78
    v_exp_f32 v79, v79
    s_nop 0
    v_cvt_pk_bf16_f32 v96, v64, v65
    v_cvt_pk_bf16_f32 v97, v66, v67
    v_cvt_pk_bf16_f32 v98, v68, v69
    v_cvt_pk_bf16_f32 v99, v70, v71
    v_cvt_pk_bf16_f32 v100, v72, v73
    v_cvt_pk_bf16_f32 v101, v74, v75
    v_cvt_pk_bf16_f32 v102, v76, v77
    v_cvt_pk_bf16_f32 v103, v78, v79
    s_nop 1
    v_mfma_f32_32x32x16_bf16 v[152:167], a[8:11], v[96:99], v[152:167]
    v_mfma_f32_32x32x16_bf16 v[152:167], a[12:15], v[100:103], v[152:167]
    s_add_u32 s43, s43, 4096
    s_cmp_lt_u32 s43, 0x10000
    s_cbranch_scc1 L_f_fbpv
    s_nop 11
    v_add_u32 v11, s72, v6
    ds_write_b128 v11, v[104:107] offset:0
    ds_write_b128 v11, v[108:111] offset:1024
    ds_write_b128 v11, v[112:115] offset:2048
    ds_write_b128 v11, v[116:119] offset:3072
    v_add_u32 v11, s73, v6
    ds_write_b128 v11, v[120:123] offset:4096
    ds_write_b128 v11, v[124:127] offset:5120
    ds_write_b128 v11, v[128:131] offset:6144
    ds_write_b128 v11, v[132:135] offset:7168
    v_add_u32 v11, s74, v6
    ds_write_b128 v11, v[136:139] offset:8192
    ds_write_b128 v11, v[140:143] offset:9216
    ds_write_b128 v11, v[144:147] offset:10240
    ds_write_b128 v11, v[148:151] offset:11264
    s_waitcnt lgkmcnt(0)
    s_barrier
    ds_read_b128 v[168:171], v12 offset:0
    ds_read_b128 v[172:175], v12 offset:1024
    ds_read_b128 v[176:179], v12 offset:2048
    ds_read_b128 v[180:183], v12 offset:3072
    ds_read_b128 v[184:187], v12 offset:4096
    ds_read_b128 v[188:191], v12 offset:5120
    ds_read_b128 v[192:195], v12 offset:6144
    ds_read_b128 v[196:199], v12 offset:7168
    ds_read_b128 v[200:203], v12 offset:8192
    ds_read_b128 v[204:207], v12 offset:9216
    ds_read_b128 v[208:211], v12 offset:10240
    ds_read_b128 v[212:215], v12 offset:11264
    s_waitcnt lgkmcnt(4)
    v_pk_add_f32 v[168:169], v[168:169], v[184:185]
    v_pk_add_f32 v[170:171], v[170:171], v[186:187]
    v_pk_add_f32 v[172:173], v[172:173], v[188:189]
    v_pk_add_f32 v[174:175], v[174:175], v[190:191]
    v_pk_add_f32 v[176:177], v[176:177], v[192:193]
    v_pk_add_f32 v[178:179], v[178:179], v[194:195]
    v_pk_add_f32 v[180:181], v[180:181], v[196:197]
    v_pk_add_f32 v[182:183], v[182:183], v[198:199]
    s_waitcnt lgkmcnt(0)
    v_pk_add_f32 v[168:169], v[168:169], v[200:201]
    v_pk_add_f32 v[170:171], v[170:171], v[202:203]
    v_pk_add_f32 v[172:173], v[172:173], v[204:205]
    v_pk_add_f32 v[174:175], v[174:175], v[206:207]
    v_pk_add_f32 v[176:177], v[176:177], v[208:209]
    v_pk_add_f32 v[178:179], v[178:179], v[210:211]
    v_pk_add_f32 v[180:181], v[180:181], v[212:213]
    v_pk_add_f32 v[182:183], v[182:183], v[214:215]
    v_pk_add_f32 v[152:153], v[152:153], v[168:169]
    v_pk_add_f32 v[154:155], v[154:155], v[170:171]
    v_pk_add_f32 v[156:157], v[156:157], v[172:173]
    v_pk_add_f32 v[158:159], v[158:159], v[174:175]
    v_pk_add_f32 v[160:161], v[160:161], v[176:177]
    v_pk_add_f32 v[162:163], v[162:163], v[178:179]
    v_pk_add_f32 v[164:165], v[164:165], v[180:181]
    v_pk_add_f32 v[166:167], v[166:167], v[182:183]
    v_mov_b32 v3, v164
    s_nop 1
    v_permlane32_swap_b32 v164, v3
    v_rcp_f32 v3, v3
    s_nop 0
    v_mul_f32 v3, v3, v10
    s_cmp_eq_u32 s46, 1
    s_cbranch_scc1 L_f_tail
    v_mul_f32 v152, v3, v152
    v_mul_f32 v153, v3, v153
    v_mul_f32 v154, v3, v154
    v_mul_f32 v155, v3, v155
    v_mul_f32 v156, v3, v156
    v_mul_f32 v157, v3, v157
    v_mul_f32 v158, v3, v158
    v_mul_f32 v159, v3, v159
    v_mul_f32 v160, v3, v160
    v_mul_f32 v161, v3, v161
    v_mul_f32 v162, v3, v162
    v_mul_f32 v163, v3, v163
    v_mul_f32 v164, v3, v164
    v_mul_f32 v165, v3, v165
    v_mul_f32 v166, v3, v166
    v_mul_f32 v167, v3, v167
    v_cvt_pk_bf16_f32 v240, v152, v153
    v_cvt_pk_bf16_f32 v241, v154, v155
    v_cvt_pk_bf16_f32 v242, v156, v157
    v_cvt_pk_bf16_f32 v243, v158, v159
    buffer_store_dwordx4 v[240:243], v6, s[16:19], s61 offen sc1
    v_cvt_pk_bf16_f32 v244, v160, v161
    v_cvt_pk_bf16_f32 v245, v162, v163
    s_mov_b64 exec, 0xffffffff
    v_cvt_pk_bf16_f32 v246, v164, v165
    v_cvt_pk_bf16_f32 v247, v166, v167
    s_mov_b64 exec, -1
    buffer_store_dwordx4 v[244:247], v6, s[16:19], s61 offen offset:1024 sc1
    s_branch L_f_tail
.section .rodata,"a"
.p2align 6
.amdhsa_kernel gated_mix__mha_block__linear_attn_block__prompt_kernel
  .amdhsa_next_free_vgpr 512
  .amdhsa_next_free_sgpr 80
  .amdhsa_accum_offset 256
  .amdhsa_group_segment_fixed_size 0
  .amdhsa_kernarg_size 80
  .amdhsa_user_sgpr_count 2
  .amdhsa_user_sgpr_kernarg_segment_ptr 1
  .amdhsa_system_sgpr_workgroup_id_x 1
  .amdhsa_float_denorm_mode_32 3
.end_amdhsa_kernel
```
